```python
import torch

def _softmax(x, axis=-1):
    return torch.softmax(x, dim=axis)
def _gelu(x):
    return torch.nn.functional.gelu(x, approximate="tanh")
def _silu(x):
    return torch.nn.functional.silu(x)
def _sigmoid(x):
    return torch.sigmoid(x)
def _layernorm(x, axis=-1, eps=1e-5):
    m = x.mean(dim=axis, keepdim=True)
    v = x.var(dim=axis, keepdim=True, unbiased=False)
    return (x - m) / torch.sqrt(v + eps)
def _scatter_add(tgt, idx, src, axis=0):
    return tgt.clone().index_add_(axis, idx, src)
def _segment_sum(src, seg, n):
    out = torch.zeros((n,) + src.shape[1:], dtype=src.dtype)
    return out.index_add_(0, seg, src)
def _pad(x, pw):
    flat = tuple(v for pair in reversed(pw) for v in pair)
    return torch.nn.functional.pad(x, flat)

kernel_name = 'sequential_preLN__mha_block_cached__glu_gated_swiglu__decode'

def setup_inputs():

    _w = (lambda a: (lambda t: t.to(torch.bfloat16) if t.is_floating_point() else t)(torch.as_tensor(a)))
    def _A_setup():
        B, Sq, D = 1, 1, 576
        H, Sk, Dh = 32, 8192, 128
        return {
            "x": _w((lambda *s: torch.randn(*s, dtype=torch.bfloat16) * 0.05)(B, Sq, D)),
            "k_cache": _w((lambda *s: torch.randn(*s, dtype=torch.bfloat16) * 1.6)(B, H, Sk, Dh)),
            "v_cache": _w((lambda *s: torch.randn(*s, dtype=torch.bfloat16) * 0.8)(B, H, Sk, Dh)),
            "wq": _w((lambda *s: torch.randn(*s, dtype=torch.bfloat16) * 1.6)(D, H * Dh) * (D ** -0.5)),
            "wo": _w((lambda *s: torch.randn(*s, dtype=torch.bfloat16) * 0.8)(H * Dh, D) * ((H * Dh) ** -0.5)),
        }
    _A_in = _A_setup()

    def _B_setup():
        B, S, D, F = 1, 1, 576, 4608
        return {
            "x": _w((lambda *s: torch.randn(*s, dtype=torch.bfloat16) * 0.05)(B, S, D)),
            "w1": _w((lambda *s: torch.randn(*s, dtype=torch.bfloat16) * 0.4)(D, F) * (2.0 / D) ** 0.5),
            "w3": _w((lambda *s: torch.randn(*s, dtype=torch.bfloat16) * 0.4)(D, F) * (2.0 / D) ** 0.5),
            "w2": _w((lambda *s: torch.randn(*s, dtype=torch.bfloat16) * 0.4)(F, D) * (2.0 / F) ** 0.5),
        }
    _B_in = _B_setup()

    return {
        "A_x": _A_in["x"],
        "A_k_cache": _A_in["k_cache"],
        "A_v_cache": _A_in["v_cache"],
        "A_wq": _A_in["wq"],
        "A_wo": _A_in["wo"],
        "B_x": _B_in["x"],
        "B_w1": _B_in["w1"],
        "B_w3": _B_in["w3"],
        "B_w2": _B_in["w2"],
    }

def reference(A_x, A_k_cache, A_v_cache, A_wq, A_wo, B_x, B_w1, B_w3, B_w2):
    def _A_ref(x, k_cache, v_cache, wq, wo):
        B, Sq, D = x.shape
        H, Dh = 32, 128
        q = (lambda x, *d: x.permute(*d))((x @ wq).reshape(B, Sq, H, Dh), 0, 2, 1, 3)
        scores = torch.einsum("bhqd,bhkd->bhqk", q, k_cache) * (Dh ** -0.5)
        p = _softmax(scores, axis=-1)
        o = torch.einsum("bhqk,bhkd->bhqd", p, v_cache)
        return (lambda x, *d: x.permute(*d))(o, 0, 2, 1, 3).reshape(B, Sq, H * Dh) @ wo

    def _B_ref(x, w1, w3, w2):
        gate = torch.einsum("bsd,df->bsf", x, w1)
        up = torch.einsum("bsd,df->bsf", x, w3)
        h = _silu(gate) * up
        out = torch.einsum("bsf,fd->bsd", h, w2)
        return out

    x = A_x
    h = x + _A_ref(_layernorm(x, axis=-1), A_k_cache, A_v_cache, A_wq, A_wo)
    h2 = h + _B_ref(_layernorm(h, axis=-1), B_w1, B_w3, B_w2)
    return h2
```

```asm
; @launch grid=(256,1,1) block=(576,1,1) lds=9216
.amdgcn_target "amdgcn-amd-amdhsa--gfx950"
.text
.globl sequential_preLN__mha_block_cached__glu_gated_swiglu__decode_kernel
.p2align 8
.type sequential_preLN__mha_block_cached__glu_gated_swiglu__decode_kernel,@function
sequential_preLN__mha_block_cached__glu_gated_swiglu__decode_kernel:
    s_cmp_ge_u32 s2, 256
    s_cbranch_scc1 L_exit
    s_load_dwordx16 s[4:19], s[0:1], 0
    s_load_dwordx8 s[20:27], s[0:1], 64
    v_lshrrev_b32 v1, 6, v0
    v_and_b32 v0, 63, v0
    v_readfirstlane_b32 s28, v1
    s_and_b32 s29, s2, 7
    s_lshl_b32 s29, s29, 2
    s_bfe_u32 s3, s2, 0x20003
    s_add_u32 s29, s29, s3
    s_lshr_b32 s30, s2, 5
    v_lshlrev_b32 v28, 4, v0
    s_movk_i32 s46, 1152
    s_mov_b32 s47, 0x20000
    s_sub_u32 s28, s28, 1
    s_cbranch_scc1 L_helper
    s_lshl_b32 s60, s29, 21
    s_lshl_b32 s61, s30, 18
    s_add_u32 s62, s60, s61
    s_mov_b32 s34, 0x40000
    s_mov_b32 s35, 0x20000
    s_mov_b32 s38, 0x40000
    s_mov_b32 s39, 0x20000
    s_lshl_b32 s3, s28, 10
    v_add_u32 v24, s3, v28
    s_mov_b32 s60, 0
    s_getreg_b32 s72, hwreg(HW_REG_XCC_ID, 0, 3)
    s_lshr_b32 s72, 170, s72
    s_and_b32 s72, s72, 1
    s_mov_b32 s73, 0
    s_waitcnt lgkmcnt(0)
    s_add_u32 s32, s6, s62
    s_addc_u32 s33, s7, 0
    buffer_load_dwordx4 v[52:55], v24, s[32:35], s60 offen nt
    s_addk_i32 s60, 0x2000
    buffer_load_dwordx4 v[56:59], v24, s[32:35], s60 offen nt
    s_addk_i32 s60, 0x2000
    buffer_load_dwordx4 v[60:63], v24, s[32:35], s60 offen nt
    s_addk_i32 s60, 0x2000
    buffer_load_dwordx4 v[64:67], v24, s[32:35], s60 offen nt
    s_addk_i32 s60, 0x2000
    s_add_u32 s36, s8, s62
    s_addc_u32 s37, s9, 0
    s_load_dword s71, s[26:27], 0
    s_mov_b32 s44, s4
    s_mov_b32 s45, s5
    s_mov_b32 s43, 0x20000
    s_mov_b32 s48, s26
    s_mov_b32 s49, s27
    s_mov_b32 s50, 0x400000
    s_mov_b32 s51, 0x20000
    s_mov_b32 s56, s22
    s_mov_b32 s57, s23
    s_movk_i32 s58, 1152
    s_mov_b32 s59, 0x20000
    s_mov_b32 s64, 0x3db504f3
    s_mov_b32 s65, 0x3fb8aa3b
    s_mov_b32 s66, 0xffff0000
    s_mov_b32 s67, 0xfffff000
    s_movk_i32 s68, 0xfff
    v_and_b32 v32, 1, v0
    v_lshlrev_b32 v32, 4, v32
    v_mov_b32 v33, 0xffff
    v_lshlrev_b32 v33, v32, v33
    v_bfe_u32 v32, v0, 1, 2
    v_cmp_eq_u32 vcc, 0, v32
    s_nop 1
    v_cndmask_b32 v4, 0, v33, vcc
    v_cmp_eq_u32 vcc, 1, v32
    s_nop 1
    v_cndmask_b32 v5, 0, v33, vcc
    v_cmp_eq_u32 vcc, 2, v32
    s_nop 1
    v_cndmask_b32 v6, 0, v33, vcc
    v_cmp_eq_u32 vcc, 3, v32
    s_nop 1
    v_cndmask_b32 v7, 0, v33, vcc
    s_lshr_b32 s24, s2, 3
    s_lshr_b32 s3, s2, 5
    s_and_b32 s78, s24, 3
    s_cmp_gt_u32 s78, 1
    s_cselect_b32 s62, 1, 0
    s_sub_u32 s62, s78, s62
    s_lshl_b32 s62, s62, 3
    s_add_u32 s62, s62, s3
    s_add_u32 s62, s62, 3
    s_add_u32 s24, s3, 24
    s_cmp_lt_u32 s3, 3
    s_cselect_b32 s24, s3, s24
    s_cmp_eq_u32 s78, 1
    s_cselect_b32 s24, s24, s62
    s_and_b32 s3, s2, 7
    s_mul_i32 s78, s3, 18
    s_add_u32 s78, s78, s24
    s_lshl_b32 s62, s24, 3
    s_add_u32 s62, s62, s3
    s_cmp_lt_u32 s24, 18
    s_cselect_b32 s79, s78, s62
    s_mov_b32 s55, 0x20000
    s_cmp_lt_u32 s79, 144
    s_cbranch_scc0 L_r1_1
    s_mov_b32 s69, s79
    s_mul_i32 s3, s69, 36864
    s_add_u32 s52, s20, s3
    s_addc_u32 s53, s21, 0
    s_mov_b32 s54, 0
    s_mov_b32 s63, 0x40000000
    s_lshl_b32 s3, s28, 7
    s_branch L_r2_1
L_r1_1:
    s_sub_u32 s69, s79, 144
    s_lshr_b32 s69, s69, 3
    s_and_b32 s3, s79, 7
    s_mul_i32 s3, s3, 589824
    s_lshl_b32 s62, s69, 7
    s_sub_u32 s54, 589824, s62
    s_add_u32 s3, s3, s62
    s_cmp_lt_u32 s79, 216
    s_cselect_b32 s54, s54, 0
    s_cselect_b32 s3, s3, 0
    s_add_u32 s52, s12, s3
    s_addc_u32 s53, s13, 0
    s_mov_b32 s63, 36864
    s_mul_i32 s3, s28, 73728
L_r2_1:
    s_movk_i32 s76, 4608
    s_add_u32 s77, s63, s76
    v_lshrrev_b32 v32, 4, v0
    v_bfe_u32 v33, v0, 3, 1
    v_lshl_add_u32 v32, v32, 3, v33
    v_mul_u32_u24 v32, 1152, v32
    v_and_b32 v33, 7, v0
    v_lshl_add_u32 v32, v33, 4, v32
    v_add_u32 v2, s3, v32
    s_cmp_lt_u32 s28, 4
    s_cbranch_scc1 L_yp
    s_setprio 1
L_yp:
    s_mov_b32 s3, s24
    s_sub_u32 s62, s3, 9
    s_cmp_lt_u32 s3, 18
    s_cselect_b32 s62, s3, s62
    s_mul_i32 s62, s62, 26
    s_sub_u32 s42, 576, s62
    s_min_u32 s42, s42, 26
    s_mul_i32 s42, s42, 9216
    s_sub_u32 s42, s42, 8064
    s_sub_u32 s3, s3, 18
    s_cmp_lt_u32 s3, 9
    s_cselect_b32 s42, 0, s42
    s_cselect_b32 s62, 0, s62
    s_mul_i32 s62, s62, 9216
    s_and_b32 s3, s2, 7
    s_mul_i32 s3, s3, 1152
    s_add_u32 s62, s62, s3
    s_bitcmp1_b32 s28, 0
    s_cselect_b32 s40, s18, s16
    s_cselect_b32 s41, s19, s17
    s_add_u32 s40, s40, s62
    s_addc_u32 s41, s41, 0
    s_mov_b32 s14, s42
    s_bitcmp1_b32 s28, 0
    s_cselect_b32 s42, 0, s42
    s_cselect_b32 s14, s14, 0
    s_mov_b64 vcc, s[72:73]
    s_lshl_b32 s3, s28, 9
    s_add_u32 s3, s3, 4096
    v_lshrrev_b32 v25, 4, v0
    v_lshlrev_b32 v25, 7, v25
    v_and_b32 v35, 7, v0
    v_lshl_add_u32 v25, v35, 4, v25
    v_add_u32 v25, s3, v25
    v_and_b32 v28, 0xf0, v28
    v_mov_b32 v26, 0xff800000
    v_mov_b32 v27, 0
    s_waitcnt vmcnt(3)
    buffer_load_dwordx4 v[68:71], v24, s[32:35], s60 offen nt
    s_addk_i32 s60, 0x2000
    s_waitcnt vmcnt(3)
    buffer_load_dwordx4 v[72:75], v24, s[32:35], s60 offen nt
    s_addk_i32 s60, 0x2000
    s_waitcnt vmcnt(3)
    s_cbranch_vccnz L_ev6
    s_waitcnt vmcnt(1)
L_ev6:
    buffer_load_dwordx4 v[76:79], v24, s[32:35], s60 offen nt
    s_addk_i32 s60, 0x2000
    s_waitcnt vmcnt(3)
    s_cbranch_vccnz L_ev7
    s_waitcnt vmcnt(1)
L_ev7:
    buffer_load_dwordx4 v[80:83], v24, s[32:35], s60 offen nt
    s_addk_i32 s60, 0x2000
    s_waitcnt vmcnt(3)
    s_cbranch_vccnz L_ev8
    s_waitcnt vmcnt(1)
L_ev8:
    buffer_load_dwordx4 v[84:87], v24, s[32:35], s60 offen nt
    s_addk_i32 s60, 0x2000
    s_waitcnt vmcnt(3)
    s_cbranch_vccnz L_ev9
    s_waitcnt vmcnt(1)
L_ev9:
    buffer_load_dwordx4 v[88:91], v24, s[32:35], s60 offen nt
    s_addk_i32 s60, 0x2000
    s_waitcnt vmcnt(3)
    s_cbranch_vccnz L_ev10
    s_waitcnt vmcnt(1)
L_ev10:
    buffer_load_dwordx4 v[92:95], v24, s[32:35], s60 offen nt
    s_addk_i32 s60, 0x2000
    s_waitcnt vmcnt(3)
    s_cbranch_vccnz L_ev11
    s_waitcnt vmcnt(1)
L_ev11:
    buffer_load_dwordx4 v[96:99], v24, s[32:35], s60 offen nt
    s_addk_i32 s60, 0x2000
    s_waitcnt vmcnt(3)
    s_cbranch_vccnz L_ev12
    s_waitcnt vmcnt(1)
L_ev12:
    buffer_load_dwordx4 v[100:103], v24, s[32:35], s60 offen nt
    s_addk_i32 s60, 0x2000
    s_waitcnt vmcnt(3)
    s_cbranch_vccnz L_ev13
    s_waitcnt vmcnt(1)
L_ev13:
    buffer_load_dwordx4 v[104:107], v24, s[32:35], s60 offen nt
    s_addk_i32 s60, 0x2000
    s_waitcnt vmcnt(3)
    s_cbranch_vccnz L_ev14
    s_waitcnt vmcnt(1)
L_ev14:
    buffer_load_dwordx4 v[108:111], v24, s[32:35], s60 offen nt
    s_addk_i32 s60, 0x2000
    s_waitcnt vmcnt(3)
    s_cbranch_vccnz L_ev15
    s_waitcnt vmcnt(1)
L_ev15:
    buffer_load_dwordx4 v[112:115], v24, s[32:35], s60 offen nt
    s_addk_i32 s60, 0x2000
    s_waitcnt vmcnt(3)
    s_cbranch_vccnz L_ev16
    s_waitcnt vmcnt(1)
L_ev16:
    buffer_load_dwordx4 v[116:119], v24, s[32:35], s60 offen nt
    s_addk_i32 s60, 0x2000
    s_waitcnt vmcnt(3)
    s_cbranch_vccnz L_ev17
    s_waitcnt vmcnt(1)
L_ev17:
    buffer_load_dwordx4 v[120:123], v24, s[32:35], s60 offen nt
    s_addk_i32 s60, 0x2000
    s_barrier
    ds_read_b128 v[8:11], v28 offset:256
    s_waitcnt lgkmcnt(0)
    s_add_u32 s71, s71, 1
    s_and_b32 s31, s71, 0xfff
    v_mov_b32 v3, s31
    v_dot2_f32_bf16 v28, v52, v8, 0
    v_dot2_f32_bf16 v28, v53, v9, v28
    v_dot2_f32_bf16 v28, v54, v10, v28
    v_dot2_f32_bf16 v28, v55, v11, v28
    v_dot2_f32_bf16 v29, v56, v8, 0
    v_dot2_f32_bf16 v29, v57, v9, v29
    v_dot2_f32_bf16 v29, v58, v10, v29
    v_dot2_f32_bf16 v29, v59, v11, v29
    v_dot2_f32_bf16 v30, v60, v8, 0
    v_dot2_f32_bf16 v30, v61, v9, v30
    v_dot2_f32_bf16 v30, v62, v10, v30
    v_dot2_f32_bf16 v30, v63, v11, v30
    v_dot2_f32_bf16 v31, v64, v8, 0
    v_dot2_f32_bf16 v31, v65, v9, v31
    v_dot2_f32_bf16 v31, v66, v10, v31
    v_dot2_f32_bf16 v31, v67, v11, v31
    v_add_f32_dpp v28, v28, v28 row_ror:8 row_mask:0xf bank_mask:0xf
    v_add_f32_dpp v29, v29, v29 row_ror:8 row_mask:0xf bank_mask:0xf
    v_add_f32_dpp v30, v30, v30 row_ror:8 row_mask:0xf bank_mask:0xf
    v_add_f32_dpp v31, v31, v31 row_ror:8 row_mask:0xf bank_mask:0xf
    v_add_f32_dpp v28, v28, v28 row_ror:4 row_mask:0xf bank_mask:0xf
    v_add_f32_dpp v29, v29, v29 row_ror:4 row_mask:0xf bank_mask:0xf
    v_add_f32_dpp v30, v30, v30 row_ror:4 row_mask:0xf bank_mask:0xf
    v_add_f32_dpp v31, v31, v31 row_ror:4 row_mask:0xf bank_mask:0xf
    v_add_f32_dpp v28, v28, v28 row_ror:2 row_mask:0xf bank_mask:0xf
    v_add_f32_dpp v29, v29, v29 row_ror:2 row_mask:0xf bank_mask:0xf
    v_add_f32_dpp v30, v30, v30 row_ror:2 row_mask:0xf bank_mask:0xf
    v_add_f32_dpp v31, v31, v31 row_ror:2 row_mask:0xf bank_mask:0xf
    v_add_f32_dpp v28, v28, v28 row_ror:1 row_mask:0xf bank_mask:0xf
    v_add_f32_dpp v29, v29, v29 row_ror:1 row_mask:0xf bank_mask:0xf
    v_add_f32_dpp v30, v30, v30 row_ror:1 row_mask:0xf bank_mask:0xf
    v_add_f32_dpp v31, v31, v31 row_ror:1 row_mask:0xf bank_mask:0xf
    v_cvt_pk_bf16_f32 v32, v28, v29
    v_cvt_pk_bf16_f32 v33, v30, v31
    v_lshlrev_b32 v28, 16, v32
    v_and_b32 v29, s66, v32
    v_lshlrev_b32 v30, 16, v33
    v_and_b32 v31, s66, v33
    v_mul_f32 v28, s64, v28
    v_mul_f32 v29, s64, v29
    v_mul_f32 v30, s64, v30
    v_mul_f32 v31, s64, v31
    v_cvt_pk_bf16_f32 v36, v28, v29
    v_cvt_pk_bf16_f32 v37, v30, v31
    v_max3_f32 v26, v26, v28, v29
    v_max3_f32 v26, v26, v30, v31
    s_waitcnt vmcnt(3)
    buffer_load_dwordx4 v[124:127], v24, s[32:35], s60 offen nt
    s_addk_i32 s60, 0x2000
    v_dot2_f32_bf16 v28, v68, v8, 0
    v_dot2_f32_bf16 v28, v69, v9, v28
    v_dot2_f32_bf16 v28, v70, v10, v28
    v_dot2_f32_bf16 v28, v71, v11, v28
    v_dot2_f32_bf16 v29, v72, v8, 0
    v_dot2_f32_bf16 v29, v73, v9, v29
    v_dot2_f32_bf16 v29, v74, v10, v29
    v_dot2_f32_bf16 v29, v75, v11, v29
    v_dot2_f32_bf16 v30, v76, v8, 0
    v_dot2_f32_bf16 v30, v77, v9, v30
    v_dot2_f32_bf16 v30, v78, v10, v30
    v_dot2_f32_bf16 v30, v79, v11, v30
    v_dot2_f32_bf16 v31, v80, v8, 0
    v_dot2_f32_bf16 v31, v81, v9, v31
    v_dot2_f32_bf16 v31, v82, v10, v31
    v_dot2_f32_bf16 v31, v83, v11, v31
    v_add_f32_dpp v28, v28, v28 row_ror:8 row_mask:0xf bank_mask:0xf
    v_add_f32_dpp v29, v29, v29 row_ror:8 row_mask:0xf bank_mask:0xf
    v_add_f32_dpp v30, v30, v30 row_ror:8 row_mask:0xf bank_mask:0xf
    v_add_f32_dpp v31, v31, v31 row_ror:8 row_mask:0xf bank_mask:0xf
    v_add_f32_dpp v28, v28, v28 row_ror:4 row_mask:0xf bank_mask:0xf
    v_add_f32_dpp v29, v29, v29 row_ror:4 row_mask:0xf bank_mask:0xf
    v_add_f32_dpp v30, v30, v30 row_ror:4 row_mask:0xf bank_mask:0xf
    v_add_f32_dpp v31, v31, v31 row_ror:4 row_mask:0xf bank_mask:0xf
    v_add_f32_dpp v28, v28, v28 row_ror:2 row_mask:0xf bank_mask:0xf
    v_add_f32_dpp v29, v29, v29 row_ror:2 row_mask:0xf bank_mask:0xf
    v_add_f32_dpp v30, v30, v30 row_ror:2 row_mask:0xf bank_mask:0xf
    v_add_f32_dpp v31, v31, v31 row_ror:2 row_mask:0xf bank_mask:0xf
    v_add_f32_dpp v28, v28, v28 row_ror:1 row_mask:0xf bank_mask:0xf
    v_add_f32_dpp v29, v29, v29 row_ror:1 row_mask:0xf bank_mask:0xf
    v_add_f32_dpp v30, v30, v30 row_ror:1 row_mask:0xf bank_mask:0xf
    v_add_f32_dpp v31, v31, v31 row_ror:1 row_mask:0xf bank_mask:0xf
    v_cvt_pk_bf16_f32 v32, v28, v29
    v_cvt_pk_bf16_f32 v33, v30, v31
    v_lshlrev_b32 v28, 16, v32
    v_and_b32 v29, s66, v32
    v_lshlrev_b32 v30, 16, v33
    v_and_b32 v31, s66, v33
    v_mul_f32 v28, s64, v28
    v_mul_f32 v29, s64, v29
    v_mul_f32 v30, s64, v30
    v_mul_f32 v31, s64, v31
    v_cvt_pk_bf16_f32 v38, v28, v29
    v_cvt_pk_bf16_f32 v39, v30, v31
    v_max3_f32 v26, v26, v28, v29
    v_max3_f32 v26, v26, v30, v31
    s_waitcnt vmcnt(3)
    buffer_load_dwordx4 v[128:131], v24, s[32:35], s60 offen nt
    s_addk_i32 s60, 0x2000
    v_dot2_f32_bf16 v28, v84, v8, 0
    v_dot2_f32_bf16 v28, v85, v9, v28
    v_dot2_f32_bf16 v28, v86, v10, v28
    v_dot2_f32_bf16 v28, v87, v11, v28
    v_dot2_f32_bf16 v29, v88, v8, 0
    v_dot2_f32_bf16 v29, v89, v9, v29
    v_dot2_f32_bf16 v29, v90, v10, v29
    v_dot2_f32_bf16 v29, v91, v11, v29
    v_dot2_f32_bf16 v30, v92, v8, 0
    v_dot2_f32_bf16 v30, v93, v9, v30
    v_dot2_f32_bf16 v30, v94, v10, v30
    v_dot2_f32_bf16 v30, v95, v11, v30
    v_dot2_f32_bf16 v31, v96, v8, 0
    v_dot2_f32_bf16 v31, v97, v9, v31
    v_dot2_f32_bf16 v31, v98, v10, v31
    v_dot2_f32_bf16 v31, v99, v11, v31
    v_add_f32_dpp v28, v28, v28 row_ror:8 row_mask:0xf bank_mask:0xf
    v_add_f32_dpp v29, v29, v29 row_ror:8 row_mask:0xf bank_mask:0xf
    v_add_f32_dpp v30, v30, v30 row_ror:8 row_mask:0xf bank_mask:0xf
    v_add_f32_dpp v31, v31, v31 row_ror:8 row_mask:0xf bank_mask:0xf
    v_add_f32_dpp v28, v28, v28 row_ror:4 row_mask:0xf bank_mask:0xf
    v_add_f32_dpp v29, v29, v29 row_ror:4 row_mask:0xf bank_mask:0xf
    v_add_f32_dpp v30, v30, v30 row_ror:4 row_mask:0xf bank_mask:0xf
    v_add_f32_dpp v31, v31, v31 row_ror:4 row_mask:0xf bank_mask:0xf
    v_add_f32_dpp v28, v28, v28 row_ror:2 row_mask:0xf bank_mask:0xf
    v_add_f32_dpp v29, v29, v29 row_ror:2 row_mask:0xf bank_mask:0xf
    v_add_f32_dpp v30, v30, v30 row_ror:2 row_mask:0xf bank_mask:0xf
    v_add_f32_dpp v31, v31, v31 row_ror:2 row_mask:0xf bank_mask:0xf
    v_add_f32_dpp v28, v28, v28 row_ror:1 row_mask:0xf bank_mask:0xf
    v_add_f32_dpp v29, v29, v29 row_ror:1 row_mask:0xf bank_mask:0xf
    v_add_f32_dpp v30, v30, v30 row_ror:1 row_mask:0xf bank_mask:0xf
    v_add_f32_dpp v31, v31, v31 row_ror:1 row_mask:0xf bank_mask:0xf
    v_cvt_pk_bf16_f32 v32, v28, v29
    v_cvt_pk_bf16_f32 v33, v30, v31
    v_lshlrev_b32 v28, 16, v32
    v_and_b32 v29, s66, v32
    v_lshlrev_b32 v30, 16, v33
    v_and_b32 v31, s66, v33
    v_mul_f32 v28, s64, v28
    v_mul_f32 v29, s64, v29
    v_mul_f32 v30, s64, v30
    v_mul_f32 v31, s64, v31
    v_cvt_pk_bf16_f32 v40, v28, v29
    v_cvt_pk_bf16_f32 v41, v30, v31
    v_max3_f32 v26, v26, v28, v29
    v_max3_f32 v26, v26, v30, v31
    s_waitcnt vmcnt(3)
    buffer_load_dwordx4 v[132:135], v24, s[32:35], s60 offen nt
    s_addk_i32 s60, 0x2000
    v_dot2_f32_bf16 v28, v100, v8, 0
    v_dot2_f32_bf16 v28, v101, v9, v28
    v_dot2_f32_bf16 v28, v102, v10, v28
    v_dot2_f32_bf16 v28, v103, v11, v28
    v_dot2_f32_bf16 v29, v104, v8, 0
    v_dot2_f32_bf16 v29, v105, v9, v29
    v_dot2_f32_bf16 v29, v106, v10, v29
    v_dot2_f32_bf16 v29, v107, v11, v29
    v_dot2_f32_bf16 v30, v108, v8, 0
    v_dot2_f32_bf16 v30, v109, v9, v30
    v_dot2_f32_bf16 v30, v110, v10, v30
    v_dot2_f32_bf16 v30, v111, v11, v30
    v_dot2_f32_bf16 v31, v112, v8, 0
    v_dot2_f32_bf16 v31, v113, v9, v31
    v_dot2_f32_bf16 v31, v114, v10, v31
    v_dot2_f32_bf16 v31, v115, v11, v31
    v_add_f32_dpp v28, v28, v28 row_ror:8 row_mask:0xf bank_mask:0xf
    v_add_f32_dpp v29, v29, v29 row_ror:8 row_mask:0xf bank_mask:0xf
    v_add_f32_dpp v30, v30, v30 row_ror:8 row_mask:0xf bank_mask:0xf
    v_add_f32_dpp v31, v31, v31 row_ror:8 row_mask:0xf bank_mask:0xf
    v_add_f32_dpp v28, v28, v28 row_ror:4 row_mask:0xf bank_mask:0xf
    v_add_f32_dpp v29, v29, v29 row_ror:4 row_mask:0xf bank_mask:0xf
    v_add_f32_dpp v30, v30, v30 row_ror:4 row_mask:0xf bank_mask:0xf
    v_add_f32_dpp v31, v31, v31 row_ror:4 row_mask:0xf bank_mask:0xf
    v_add_f32_dpp v28, v28, v28 row_ror:2 row_mask:0xf bank_mask:0xf
    v_add_f32_dpp v29, v29, v29 row_ror:2 row_mask:0xf bank_mask:0xf
    v_add_f32_dpp v30, v30, v30 row_ror:2 row_mask:0xf bank_mask:0xf
    v_add_f32_dpp v31, v31, v31 row_ror:2 row_mask:0xf bank_mask:0xf
    v_add_f32_dpp v28, v28, v28 row_ror:1 row_mask:0xf bank_mask:0xf
    v_add_f32_dpp v29, v29, v29 row_ror:1 row_mask:0xf bank_mask:0xf
    v_add_f32_dpp v30, v30, v30 row_ror:1 row_mask:0xf bank_mask:0xf
    v_add_f32_dpp v31, v31, v31 row_ror:1 row_mask:0xf bank_mask:0xf
    v_cvt_pk_bf16_f32 v32, v28, v29
    v_cvt_pk_bf16_f32 v33, v30, v31
    v_lshlrev_b32 v28, 16, v32
    v_and_b32 v29, s66, v32
    v_lshlrev_b32 v30, 16, v33
    v_and_b32 v31, s66, v33
    v_mul_f32 v28, s64, v28
    v_mul_f32 v29, s64, v29
    v_mul_f32 v30, s64, v30
    v_mul_f32 v31, s64, v31
    v_cvt_pk_bf16_f32 v42, v28, v29
    v_cvt_pk_bf16_f32 v43, v30, v31
    v_max3_f32 v26, v26, v28, v29
    v_max3_f32 v26, v26, v30, v31
    s_waitcnt vmcnt(3)
    buffer_load_dwordx4 v[136:139], v24, s[32:35], s60 offen nt
    s_addk_i32 s60, 0x2000
    s_waitcnt vmcnt(3)
    buffer_load_dwordx4 v[140:143], v24, s[32:35], s60 offen nt
    s_addk_i32 s60, 0x2000
    s_waitcnt vmcnt(3)
    buffer_load_dwordx4 v[144:147], v24, s[32:35], s60 offen nt
    s_addk_i32 s60, 0x2000
    v_dot2_f32_bf16 v28, v116, v8, 0
    v_dot2_f32_bf16 v28, v117, v9, v28
    v_dot2_f32_bf16 v28, v118, v10, v28
    v_dot2_f32_bf16 v28, v119, v11, v28
    v_dot2_f32_bf16 v29, v120, v8, 0
    v_dot2_f32_bf16 v29, v121, v9, v29
    v_dot2_f32_bf16 v29, v122, v10, v29
    v_dot2_f32_bf16 v29, v123, v11, v29
    v_dot2_f32_bf16 v30, v124, v8, 0
    v_dot2_f32_bf16 v30, v125, v9, v30
    v_dot2_f32_bf16 v30, v126, v10, v30
    v_dot2_f32_bf16 v30, v127, v11, v30
    v_dot2_f32_bf16 v31, v128, v8, 0
    v_dot2_f32_bf16 v31, v129, v9, v31
    v_dot2_f32_bf16 v31, v130, v10, v31
    v_dot2_f32_bf16 v31, v131, v11, v31
    v_add_f32_dpp v28, v28, v28 row_ror:8 row_mask:0xf bank_mask:0xf
    v_add_f32_dpp v29, v29, v29 row_ror:8 row_mask:0xf bank_mask:0xf
    v_add_f32_dpp v30, v30, v30 row_ror:8 row_mask:0xf bank_mask:0xf
    v_add_f32_dpp v31, v31, v31 row_ror:8 row_mask:0xf bank_mask:0xf
    v_add_f32_dpp v28, v28, v28 row_ror:4 row_mask:0xf bank_mask:0xf
    v_add_f32_dpp v29, v29, v29 row_ror:4 row_mask:0xf bank_mask:0xf
    v_add_f32_dpp v30, v30, v30 row_ror:4 row_mask:0xf bank_mask:0xf
    v_add_f32_dpp v31, v31, v31 row_ror:4 row_mask:0xf bank_mask:0xf
    v_add_f32_dpp v28, v28, v28 row_ror:2 row_mask:0xf bank_mask:0xf
    v_add_f32_dpp v29, v29, v29 row_ror:2 row_mask:0xf bank_mask:0xf
    v_add_f32_dpp v30, v30, v30 row_ror:2 row_mask:0xf bank_mask:0xf
    v_add_f32_dpp v31, v31, v31 row_ror:2 row_mask:0xf bank_mask:0xf
    v_add_f32_dpp v28, v28, v28 row_ror:1 row_mask:0xf bank_mask:0xf
    v_add_f32_dpp v29, v29, v29 row_ror:1 row_mask:0xf bank_mask:0xf
    v_add_f32_dpp v30, v30, v30 row_ror:1 row_mask:0xf bank_mask:0xf
    v_add_f32_dpp v31, v31, v31 row_ror:1 row_mask:0xf bank_mask:0xf
    v_cvt_pk_bf16_f32 v32, v28, v29
    v_cvt_pk_bf16_f32 v33, v30, v31
    v_lshlrev_b32 v28, 16, v32
    v_and_b32 v29, s66, v32
    v_lshlrev_b32 v30, 16, v33
    v_and_b32 v31, s66, v33
    v_mul_f32 v28, s64, v28
    v_mul_f32 v29, s64, v29
    v_mul_f32 v30, s64, v30
    v_mul_f32 v31, s64, v31
    v_cvt_pk_bf16_f32 v44, v28, v29
    v_cvt_pk_bf16_f32 v45, v30, v31
    v_max3_f32 v26, v26, v28, v29
    v_max3_f32 v26, v26, v30, v31
    s_waitcnt vmcnt(3)
    buffer_load_dwordx4 v[148:151], v24, s[32:35], s60 offen nt
    s_addk_i32 s60, 0x2000
    s_waitcnt vmcnt(3)
    buffer_load_dwordx4 v[152:155], v24, s[32:35], s60 offen nt
    s_addk_i32 s60, 0x2000
    s_waitcnt vmcnt(3)
    buffer_load_dwordx4 v[156:159], v24, s[32:35], s60 offen nt
    s_addk_i32 s60, 0x2000
    s_waitcnt vmcnt(3)
    buffer_load_dwordx4 v[160:163], v24, s[32:35], s60 offen nt
    s_addk_i32 s60, 0x2000
    v_dot2_f32_bf16 v28, v132, v8, 0
    v_dot2_f32_bf16 v28, v133, v9, v28
    v_dot2_f32_bf16 v28, v134, v10, v28
    v_dot2_f32_bf16 v28, v135, v11, v28
    v_dot2_f32_bf16 v29, v136, v8, 0
    v_dot2_f32_bf16 v29, v137, v9, v29
    v_dot2_f32_bf16 v29, v138, v10, v29
    v_dot2_f32_bf16 v29, v139, v11, v29
    v_dot2_f32_bf16 v30, v140, v8, 0
    v_dot2_f32_bf16 v30, v141, v9, v30
    v_dot2_f32_bf16 v30, v142, v10, v30
    v_dot2_f32_bf16 v30, v143, v11, v30
    v_dot2_f32_bf16 v31, v144, v8, 0
    v_dot2_f32_bf16 v31, v145, v9, v31
    v_dot2_f32_bf16 v31, v146, v10, v31
    v_dot2_f32_bf16 v31, v147, v11, v31
    v_add_f32_dpp v28, v28, v28 row_ror:8 row_mask:0xf bank_mask:0xf
    v_add_f32_dpp v29, v29, v29 row_ror:8 row_mask:0xf bank_mask:0xf
    v_add_f32_dpp v30, v30, v30 row_ror:8 row_mask:0xf bank_mask:0xf
    v_add_f32_dpp v31, v31, v31 row_ror:8 row_mask:0xf bank_mask:0xf
    v_add_f32_dpp v28, v28, v28 row_ror:4 row_mask:0xf bank_mask:0xf
    v_add_f32_dpp v29, v29, v29 row_ror:4 row_mask:0xf bank_mask:0xf
    v_add_f32_dpp v30, v30, v30 row_ror:4 row_mask:0xf bank_mask:0xf
    v_add_f32_dpp v31, v31, v31 row_ror:4 row_mask:0xf bank_mask:0xf
    v_add_f32_dpp v28, v28, v28 row_ror:2 row_mask:0xf bank_mask:0xf
    v_add_f32_dpp v29, v29, v29 row_ror:2 row_mask:0xf bank_mask:0xf
    v_add_f32_dpp v30, v30, v30 row_ror:2 row_mask:0xf bank_mask:0xf
    v_add_f32_dpp v31, v31, v31 row_ror:2 row_mask:0xf bank_mask:0xf
    v_add_f32_dpp v28, v28, v28 row_ror:1 row_mask:0xf bank_mask:0xf
    v_add_f32_dpp v29, v29, v29 row_ror:1 row_mask:0xf bank_mask:0xf
    v_add_f32_dpp v30, v30, v30 row_ror:1 row_mask:0xf bank_mask:0xf
    v_add_f32_dpp v31, v31, v31 row_ror:1 row_mask:0xf bank_mask:0xf
    v_cvt_pk_bf16_f32 v32, v28, v29
    v_cvt_pk_bf16_f32 v33, v30, v31
    v_lshlrev_b32 v28, 16, v32
    v_and_b32 v29, s66, v32
    v_lshlrev_b32 v30, 16, v33
    v_and_b32 v31, s66, v33
    v_mul_f32 v28, s64, v28
    v_mul_f32 v29, s64, v29
    v_mul_f32 v30, s64, v30
    v_mul_f32 v31, s64, v31
    v_cvt_pk_bf16_f32 v46, v28, v29
    v_cvt_pk_bf16_f32 v47, v30, v31
    v_max3_f32 v26, v26, v28, v29
    v_max3_f32 v26, v26, v30, v31
    s_waitcnt vmcnt(3)
    buffer_load_dwordx4 v[164:167], v24, s[32:35], s60 offen nt
    s_addk_i32 s60, 0x2000
    s_waitcnt vmcnt(3)
    buffer_load_dwordx4 v[52:55], v24, s[32:35], s60 offen nt
    s_addk_i32 s60, 0x2000
    s_waitcnt vmcnt(3)
    buffer_load_dwordx4 v[56:59], v24, s[32:35], s60 offen nt
    s_addk_i32 s60, 0x2000
    s_waitcnt vmcnt(3)
    buffer_load_dwordx4 v[60:63], v24, s[32:35], s60 offen nt
    s_addk_i32 s60, 0x2000
    v_dot2_f32_bf16 v28, v148, v8, 0
    v_dot2_f32_bf16 v28, v149, v9, v28
    v_dot2_f32_bf16 v28, v150, v10, v28
    v_dot2_f32_bf16 v28, v151, v11, v28
    v_dot2_f32_bf16 v29, v152, v8, 0
    v_dot2_f32_bf16 v29, v153, v9, v29
    v_dot2_f32_bf16 v29, v154, v10, v29
    v_dot2_f32_bf16 v29, v155, v11, v29
    v_dot2_f32_bf16 v30, v156, v8, 0
    v_dot2_f32_bf16 v30, v157, v9, v30
    v_dot2_f32_bf16 v30, v158, v10, v30
    v_dot2_f32_bf16 v30, v159, v11, v30
    v_dot2_f32_bf16 v31, v160, v8, 0
    v_dot2_f32_bf16 v31, v161, v9, v31
    v_dot2_f32_bf16 v31, v162, v10, v31
    v_dot2_f32_bf16 v31, v163, v11, v31
    v_add_f32_dpp v28, v28, v28 row_ror:8 row_mask:0xf bank_mask:0xf
    v_add_f32_dpp v29, v29, v29 row_ror:8 row_mask:0xf bank_mask:0xf
    v_add_f32_dpp v30, v30, v30 row_ror:8 row_mask:0xf bank_mask:0xf
    v_add_f32_dpp v31, v31, v31 row_ror:8 row_mask:0xf bank_mask:0xf
    v_add_f32_dpp v28, v28, v28 row_ror:4 row_mask:0xf bank_mask:0xf
    v_add_f32_dpp v29, v29, v29 row_ror:4 row_mask:0xf bank_mask:0xf
    v_add_f32_dpp v30, v30, v30 row_ror:4 row_mask:0xf bank_mask:0xf
    v_add_f32_dpp v31, v31, v31 row_ror:4 row_mask:0xf bank_mask:0xf
    v_add_f32_dpp v28, v28, v28 row_ror:2 row_mask:0xf bank_mask:0xf
    v_add_f32_dpp v29, v29, v29 row_ror:2 row_mask:0xf bank_mask:0xf
    v_add_f32_dpp v30, v30, v30 row_ror:2 row_mask:0xf bank_mask:0xf
    v_add_f32_dpp v31, v31, v31 row_ror:2 row_mask:0xf bank_mask:0xf
    v_add_f32_dpp v28, v28, v28 row_ror:1 row_mask:0xf bank_mask:0xf
    v_add_f32_dpp v29, v29, v29 row_ror:1 row_mask:0xf bank_mask:0xf
    v_add_f32_dpp v30, v30, v30 row_ror:1 row_mask:0xf bank_mask:0xf
    v_add_f32_dpp v31, v31, v31 row_ror:1 row_mask:0xf bank_mask:0xf
    v_cvt_pk_bf16_f32 v32, v28, v29
    v_cvt_pk_bf16_f32 v33, v30, v31
    v_lshlrev_b32 v28, 16, v32
    v_and_b32 v29, s66, v32
    v_lshlrev_b32 v30, 16, v33
    v_and_b32 v31, s66, v33
    v_mul_f32 v28, s64, v28
    v_mul_f32 v29, s64, v29
    v_mul_f32 v30, s64, v30
    v_mul_f32 v31, s64, v31
    v_cvt_pk_bf16_f32 v48, v28, v29
    v_cvt_pk_bf16_f32 v49, v30, v31
    v_max3_f32 v26, v26, v28, v29
    v_max3_f32 v26, v26, v30, v31
    s_waitcnt vmcnt(3)
    s_mov_b32 s60, 0
    buffer_load_dwordx4 v[64:67], v24, s[36:39], s60 offen nt
    s_addk_i32 s60, 0x2000
    s_waitcnt vmcnt(3)
    buffer_load_dwordx4 v[68:71], v24, s[36:39], s60 offen nt
    s_addk_i32 s60, 0x2000
    s_waitcnt vmcnt(3)
    buffer_load_dwordx4 v[72:75], v24, s[36:39], s60 offen nt
    s_addk_i32 s60, 0x2000
    s_waitcnt vmcnt(3)
    buffer_load_dwordx4 v[76:79], v24, s[36:39], s60 offen nt
    s_addk_i32 s60, 0x2000
    v_dot2_f32_bf16 v28, v164, v8, 0
    v_dot2_f32_bf16 v28, v165, v9, v28
    v_dot2_f32_bf16 v28, v166, v10, v28
    v_dot2_f32_bf16 v28, v167, v11, v28
    v_dot2_f32_bf16 v29, v52, v8, 0
    v_dot2_f32_bf16 v29, v53, v9, v29
    v_dot2_f32_bf16 v29, v54, v10, v29
    v_dot2_f32_bf16 v29, v55, v11, v29
    v_dot2_f32_bf16 v30, v56, v8, 0
    v_dot2_f32_bf16 v30, v57, v9, v30
    v_dot2_f32_bf16 v30, v58, v10, v30
    v_dot2_f32_bf16 v30, v59, v11, v30
    v_dot2_f32_bf16 v31, v60, v8, 0
    v_dot2_f32_bf16 v31, v61, v9, v31
    v_dot2_f32_bf16 v31, v62, v10, v31
    v_dot2_f32_bf16 v31, v63, v11, v31
    v_add_f32_dpp v28, v28, v28 row_ror:8 row_mask:0xf bank_mask:0xf
    v_add_f32_dpp v29, v29, v29 row_ror:8 row_mask:0xf bank_mask:0xf
    v_add_f32_dpp v30, v30, v30 row_ror:8 row_mask:0xf bank_mask:0xf
    v_add_f32_dpp v31, v31, v31 row_ror:8 row_mask:0xf bank_mask:0xf
    v_add_f32_dpp v28, v28, v28 row_ror:4 row_mask:0xf bank_mask:0xf
    v_add_f32_dpp v29, v29, v29 row_ror:4 row_mask:0xf bank_mask:0xf
    v_add_f32_dpp v30, v30, v30 row_ror:4 row_mask:0xf bank_mask:0xf
    v_add_f32_dpp v31, v31, v31 row_ror:4 row_mask:0xf bank_mask:0xf
    v_add_f32_dpp v28, v28, v28 row_ror:2 row_mask:0xf bank_mask:0xf
    v_add_f32_dpp v29, v29, v29 row_ror:2 row_mask:0xf bank_mask:0xf
    v_add_f32_dpp v30, v30, v30 row_ror:2 row_mask:0xf bank_mask:0xf
    v_add_f32_dpp v31, v31, v31 row_ror:2 row_mask:0xf bank_mask:0xf
    v_add_f32_dpp v28, v28, v28 row_ror:1 row_mask:0xf bank_mask:0xf
    v_add_f32_dpp v29, v29, v29 row_ror:1 row_mask:0xf bank_mask:0xf
    v_add_f32_dpp v30, v30, v30 row_ror:1 row_mask:0xf bank_mask:0xf
    v_add_f32_dpp v31, v31, v31 row_ror:1 row_mask:0xf bank_mask:0xf
    v_cvt_pk_bf16_f32 v32, v28, v29
    v_cvt_pk_bf16_f32 v33, v30, v31
    v_lshlrev_b32 v28, 16, v32
    v_and_b32 v29, s66, v32
    v_lshlrev_b32 v30, 16, v33
    v_and_b32 v31, s66, v33
    v_mul_f32 v28, s64, v28
    v_mul_f32 v29, s64, v29
    v_mul_f32 v30, s64, v30
    v_mul_f32 v31, s64, v31
    v_cvt_pk_bf16_f32 v50, v28, v29
    v_cvt_pk_bf16_f32 v51, v30, v31
    v_max3_f32 v26, v26, v28, v29
    v_max3_f32 v26, v26, v30, v31
    v_mov_b32 v28, v26
    s_nop 1
    v_permlane16_swap_b32 v26, v28
    v_max_f32 v26, v26, v28
    v_mov_b32 v28, v26
    s_nop 1
    v_permlane32_swap_b32 v26, v28
    v_max_f32 v26, v26, v28
    v_cvt_pk_bf16_f32 v26, v26, v26
    v_and_b32 v26, s66, v26
    s_lshl_b32 s3, s28, 2
    v_mov_b32 v28, s3
    ds_write_b32 v28, v26 offset:128
    v_mul_f32 v1, s65, v26
    s_setprio 0
    v_lshlrev_b32 v33, 16, v36
    v_and_b32 v34, s66, v36
    v_fma_f32 v33, v33, s65, -v1
    v_fma_f32 v34, v34, s65, -v1
    v_exp_f32 v33, v33
    v_exp_f32 v34, v34
    v_cvt_pk_bf16_f32 v28, v33, v33
    v_add_f32 v27, v27, v33
    v_and_b32 v16, v28, v4
    v_and_b32 v17, v28, v5
    v_and_b32 v18, v28, v6
    v_and_b32 v19, v28, v7
    s_waitcnt vmcnt(3)
    buffer_load_dwordx4 v[80:83], v24, s[36:39], s60 offen nt
    s_addk_i32 s60, 0x2000
    v_mfma_f32_16x16x32_bf16 v[12:15], v[64:67], v[16:19], 0
    v_cvt_pk_bf16_f32 v28, v34, v34
    v_add_f32 v27, v27, v34
    v_and_b32 v20, v28, v4
    v_and_b32 v21, v28, v5
    v_and_b32 v22, v28, v6
    v_and_b32 v23, v28, v7
    s_waitcnt vmcnt(3)
    buffer_load_dwordx4 v[84:87], v24, s[36:39], s60 offen nt
    s_addk_i32 s60, 0x2000
    v_mfma_f32_16x16x32_bf16 v[12:15], v[68:71], v[20:23], v[12:15]
    v_lshlrev_b32 v33, 16, v37
    v_and_b32 v34, s66, v37
    v_fma_f32 v33, v33, s65, -v1
    v_fma_f32 v34, v34, s65, -v1
    v_exp_f32 v33, v33
    v_exp_f32 v34, v34
    v_cvt_pk_bf16_f32 v28, v33, v33
    v_add_f32 v27, v27, v33
    v_and_b32 v16, v28, v4
    v_and_b32 v17, v28, v5
    v_and_b32 v18, v28, v6
    v_and_b32 v19, v28, v7
    s_waitcnt vmcnt(3)
    buffer_load_dwordx4 v[88:91], v24, s[36:39], s60 offen nt
    s_addk_i32 s60, 0x2000
    v_mfma_f32_16x16x32_bf16 v[12:15], v[72:75], v[16:19], v[12:15]
    v_cvt_pk_bf16_f32 v28, v34, v34
    v_add_f32 v27, v27, v34
    v_and_b32 v20, v28, v4
    v_and_b32 v21, v28, v5
    v_and_b32 v22, v28, v6
    v_and_b32 v23, v28, v7
    s_waitcnt vmcnt(3)
    buffer_load_dwordx4 v[92:95], v24, s[36:39], s60 offen nt
    s_addk_i32 s60, 0x2000
    v_mfma_f32_16x16x32_bf16 v[12:15], v[76:79], v[20:23], v[12:15]
    v_lshlrev_b32 v33, 16, v38
    v_and_b32 v34, s66, v38
    v_fma_f32 v33, v33, s65, -v1
    v_fma_f32 v34, v34, s65, -v1
    v_exp_f32 v33, v33
    v_exp_f32 v34, v34
    v_cvt_pk_bf16_f32 v28, v33, v33
    v_add_f32 v27, v27, v33
    v_and_b32 v16, v28, v4
    v_and_b32 v17, v28, v5
    v_and_b32 v18, v28, v6
    v_and_b32 v19, v28, v7
    s_waitcnt vmcnt(3)
    buffer_load_dwordx4 v[96:99], v24, s[36:39], s60 offen nt
    s_addk_i32 s60, 0x2000
    v_mfma_f32_16x16x32_bf16 v[12:15], v[80:83], v[16:19], v[12:15]
    v_cvt_pk_bf16_f32 v28, v34, v34
    v_add_f32 v27, v27, v34
    v_and_b32 v20, v28, v4
    v_and_b32 v21, v28, v5
    v_and_b32 v22, v28, v6
    v_and_b32 v23, v28, v7
    s_waitcnt vmcnt(3)
    buffer_load_dwordx4 v[100:103], v24, s[36:39], s60 offen nt
    s_addk_i32 s60, 0x2000
    v_mfma_f32_16x16x32_bf16 v[12:15], v[84:87], v[20:23], v[12:15]
    v_lshlrev_b32 v33, 16, v39
    v_and_b32 v34, s66, v39
    v_fma_f32 v33, v33, s65, -v1
    v_fma_f32 v34, v34, s65, -v1
    v_exp_f32 v33, v33
    v_exp_f32 v34, v34
    v_cvt_pk_bf16_f32 v28, v33, v33
    v_add_f32 v27, v27, v33
    v_and_b32 v16, v28, v4
    v_and_b32 v17, v28, v5
    v_and_b32 v18, v28, v6
    v_and_b32 v19, v28, v7
    s_waitcnt vmcnt(3)
    buffer_load_dwordx4 v[104:107], v24, s[36:39], s60 offen nt
    s_addk_i32 s60, 0x2000
    v_mfma_f32_16x16x32_bf16 v[12:15], v[88:91], v[16:19], v[12:15]
    v_cvt_pk_bf16_f32 v28, v34, v34
    v_add_f32 v27, v27, v34
    v_and_b32 v20, v28, v4
    v_and_b32 v21, v28, v5
    v_and_b32 v22, v28, v6
    v_and_b32 v23, v28, v7
    s_waitcnt vmcnt(3)
    buffer_load_dwordx4 v[108:111], v24, s[36:39], s60 offen nt
    s_addk_i32 s60, 0x2000
    v_mfma_f32_16x16x32_bf16 v[12:15], v[92:95], v[20:23], v[12:15]
    v_lshlrev_b32 v33, 16, v40
    v_and_b32 v34, s66, v40
    v_fma_f32 v33, v33, s65, -v1
    v_fma_f32 v34, v34, s65, -v1
    v_exp_f32 v33, v33
    v_exp_f32 v34, v34
    v_cvt_pk_bf16_f32 v28, v33, v33
    v_add_f32 v27, v27, v33
    v_and_b32 v16, v28, v4
    v_and_b32 v17, v28, v5
    v_and_b32 v18, v28, v6
    v_and_b32 v19, v28, v7
    s_waitcnt vmcnt(3)
    buffer_load_dwordx4 v[112:115], v24, s[36:39], s60 offen nt
    s_addk_i32 s60, 0x2000
    v_mfma_f32_16x16x32_bf16 v[12:15], v[96:99], v[16:19], v[12:15]
    v_cvt_pk_bf16_f32 v28, v34, v34
    v_add_f32 v27, v27, v34
    v_and_b32 v20, v28, v4
    v_and_b32 v21, v28, v5
    v_and_b32 v22, v28, v6
    v_and_b32 v23, v28, v7
    s_waitcnt vmcnt(3)
    buffer_load_dwordx4 v[116:119], v24, s[36:39], s60 offen nt
    s_addk_i32 s60, 0x2000
    v_mfma_f32_16x16x32_bf16 v[12:15], v[100:103], v[20:23], v[12:15]
    s_waitcnt lgkmcnt(0)
    s_barrier
    v_mov_b32 v28, 0
    ds_read_b128 v[8:11], v28 offset:128
    ds_read_b128 v[30:33], v28 offset:144
    s_waitcnt lgkmcnt(0)
    v_max3_f32 v29, v8, v9, v10
    v_max3_f32 v29, v29, v11, v30
    v_max3_f32 v29, v29, v31, v32
    v_max_f32 v29, v29, v33
    v_sub_f32 v26, v26, v29
    v_mul_f32 v26, s65, v26
    v_exp_f32 v26, v26
    v_mul_f32 v1, s65, v29
    s_lshr_b32 s3, s28, 1
    s_lshl_b32 s3, s3, 6
    v_add_u32 v29, s3, v0
    s_mov_b32 s3, 477218589
    v_mul_hi_u32 v30, v29, s3
    v_mul_u32_u24 v31, 9, v30
    v_sub_u32 v29, v29, v31
    v_mul_u32_u24 v30, 9216, v30
    v_lshl_add_u32 v36, v29, 7, v30
    v_mul_f32 v27, v27, v26
    v_mul_f32 v12, v12, v26
    v_mul_f32 v13, v13, v26
    v_mul_f32 v14, v14, v26
    v_mul_f32 v15, v15, v26
    v_lshlrev_b32 v33, 16, v41
    v_and_b32 v34, s66, v41
    v_fma_f32 v33, v33, s65, -v1
    v_fma_f32 v34, v34, s65, -v1
    v_exp_f32 v33, v33
    v_exp_f32 v34, v34
    v_cvt_pk_bf16_f32 v28, v33, v33
    v_add_f32 v27, v27, v33
    v_and_b32 v16, v28, v4
    v_and_b32 v17, v28, v5
    v_and_b32 v18, v28, v6
    v_and_b32 v19, v28, v7
    s_waitcnt vmcnt(3)
    buffer_load_dwordx4 v[120:123], v24, s[36:39], s60 offen nt
    s_addk_i32 s60, 0x2000
    v_mfma_f32_16x16x32_bf16 v[12:15], v[104:107], v[16:19], v[12:15]
    v_cvt_pk_bf16_f32 v28, v34, v34
    v_add_f32 v27, v27, v34
    v_and_b32 v20, v28, v4
    v_and_b32 v21, v28, v5
    v_and_b32 v22, v28, v6
    v_and_b32 v23, v28, v7
    s_waitcnt vmcnt(3)
    buffer_load_dwordx4 v[124:127], v24, s[36:39], s60 offen nt
    s_addk_i32 s60, 0x2000
    v_mfma_f32_16x16x32_bf16 v[12:15], v[108:111], v[20:23], v[12:15]
    v_lshlrev_b32 v33, 16, v42
    v_and_b32 v34, s66, v42
    v_fma_f32 v33, v33, s65, -v1
    v_fma_f32 v34, v34, s65, -v1
    v_exp_f32 v33, v33
    v_exp_f32 v34, v34
    v_cvt_pk_bf16_f32 v28, v33, v33
    v_add_f32 v27, v27, v33
    v_and_b32 v16, v28, v4
    v_and_b32 v17, v28, v5
    v_and_b32 v18, v28, v6
    v_and_b32 v19, v28, v7
    s_waitcnt vmcnt(3)
    buffer_load_dwordx4 v[128:131], v24, s[36:39], s60 offen nt
    s_addk_i32 s60, 0x2000
    v_mfma_f32_16x16x32_bf16 v[12:15], v[112:115], v[16:19], v[12:15]
    v_cvt_pk_bf16_f32 v28, v34, v34
    v_add_f32 v27, v27, v34
    v_and_b32 v20, v28, v4
    v_and_b32 v21, v28, v5
    v_and_b32 v22, v28, v6
    v_and_b32 v23, v28, v7
    s_waitcnt vmcnt(3)
    buffer_load_dwordx4 v[132:135], v24, s[36:39], s60 offen nt
    s_addk_i32 s60, 0x2000
    v_mfma_f32_16x16x32_bf16 v[12:15], v[116:119], v[20:23], v[12:15]
    v_lshlrev_b32 v33, 16, v43
    v_and_b32 v34, s66, v43
    v_fma_f32 v33, v33, s65, -v1
    v_fma_f32 v34, v34, s65, -v1
    v_exp_f32 v33, v33
    v_exp_f32 v34, v34
    v_cvt_pk_bf16_f32 v28, v33, v33
    v_add_f32 v27, v27, v33
    v_and_b32 v16, v28, v4
    v_and_b32 v17, v28, v5
    v_and_b32 v18, v28, v6
    v_and_b32 v19, v28, v7
    s_waitcnt vmcnt(3)
    buffer_load_dwordx4 v[136:139], v24, s[36:39], s60 offen nt
    s_addk_i32 s60, 0x2000
    v_mfma_f32_16x16x32_bf16 v[12:15], v[120:123], v[16:19], v[12:15]
    v_cvt_pk_bf16_f32 v28, v34, v34
    v_add_f32 v27, v27, v34
    v_and_b32 v20, v28, v4
    v_and_b32 v21, v28, v5
    v_and_b32 v22, v28, v6
    v_and_b32 v23, v28, v7
    s_waitcnt vmcnt(3)
    buffer_load_dwordx4 v[140:143], v24, s[36:39], s60 offen nt
    s_addk_i32 s60, 0x2000
    v_mfma_f32_16x16x32_bf16 v[12:15], v[124:127], v[20:23], v[12:15]
    v_lshlrev_b32 v33, 16, v44
    v_and_b32 v34, s66, v44
    v_fma_f32 v33, v33, s65, -v1
    v_fma_f32 v34, v34, s65, -v1
    v_exp_f32 v33, v33
    v_exp_f32 v34, v34
    v_cvt_pk_bf16_f32 v28, v33, v33
    v_add_f32 v27, v27, v33
    v_and_b32 v16, v28, v4
    v_and_b32 v17, v28, v5
    v_and_b32 v18, v28, v6
    v_and_b32 v19, v28, v7
    s_waitcnt vmcnt(3)
    buffer_load_dwordx4 v[144:147], v24, s[36:39], s60 offen nt
    s_addk_i32 s60, 0x2000
    v_mfma_f32_16x16x32_bf16 v[12:15], v[128:131], v[16:19], v[12:15]
    v_cvt_pk_bf16_f32 v28, v34, v34
    v_add_f32 v27, v27, v34
    v_and_b32 v20, v28, v4
    v_and_b32 v21, v28, v5
    v_and_b32 v22, v28, v6
    v_and_b32 v23, v28, v7
    s_waitcnt vmcnt(3)
    buffer_load_dwordx4 v[148:151], v24, s[36:39], s60 offen nt
    s_addk_i32 s60, 0x2000
    v_mfma_f32_16x16x32_bf16 v[12:15], v[132:135], v[20:23], v[12:15]
    v_lshlrev_b32 v33, 16, v45
    v_and_b32 v34, s66, v45
    v_fma_f32 v33, v33, s65, -v1
    v_fma_f32 v34, v34, s65, -v1
    v_exp_f32 v33, v33
    v_exp_f32 v34, v34
    v_cvt_pk_bf16_f32 v28, v33, v33
    v_add_f32 v27, v27, v33
    v_and_b32 v16, v28, v4
    v_and_b32 v17, v28, v5
    v_and_b32 v18, v28, v6
    v_and_b32 v19, v28, v7
    s_waitcnt vmcnt(3)
    buffer_load_dwordx4 v[152:155], v24, s[36:39], s60 offen nt
    s_addk_i32 s60, 0x2000
    v_mfma_f32_16x16x32_bf16 v[12:15], v[136:139], v[16:19], v[12:15]
    v_cvt_pk_bf16_f32 v28, v34, v34
    v_add_f32 v27, v27, v34
    v_and_b32 v20, v28, v4
    v_and_b32 v21, v28, v5
    v_and_b32 v22, v28, v6
    v_and_b32 v23, v28, v7
    s_waitcnt vmcnt(3)
    buffer_load_dwordx4 v[156:159], v24, s[36:39], s60 offen nt
    s_addk_i32 s60, 0x2000
    v_mfma_f32_16x16x32_bf16 v[12:15], v[140:143], v[20:23], v[12:15]
    v_lshlrev_b32 v33, 16, v46
    v_and_b32 v34, s66, v46
    v_fma_f32 v33, v33, s65, -v1
    v_fma_f32 v34, v34, s65, -v1
    v_exp_f32 v33, v33
    v_exp_f32 v34, v34
    v_cvt_pk_bf16_f32 v28, v33, v33
    v_add_f32 v27, v27, v33
    v_and_b32 v16, v28, v4
    v_and_b32 v17, v28, v5
    v_and_b32 v18, v28, v6
    v_and_b32 v19, v28, v7
    s_waitcnt vmcnt(3)
    buffer_load_dwordx4 v[160:163], v24, s[36:39], s60 offen nt
    s_addk_i32 s60, 0x2000
    v_mfma_f32_16x16x32_bf16 v[12:15], v[144:147], v[16:19], v[12:15]
    v_cvt_pk_bf16_f32 v28, v34, v34
    v_add_f32 v27, v27, v34
    v_and_b32 v20, v28, v4
    v_and_b32 v21, v28, v5
    v_and_b32 v22, v28, v6
    v_and_b32 v23, v28, v7
    s_waitcnt vmcnt(3)
    buffer_load_dwordx4 v[164:167], v24, s[36:39], s60 offen nt
    s_addk_i32 s60, 0x2000
    v_mfma_f32_16x16x32_bf16 v[12:15], v[148:151], v[20:23], v[12:15]
    v_lshlrev_b32 v33, 16, v47
    v_and_b32 v34, s66, v47
    v_fma_f32 v33, v33, s65, -v1
    v_fma_f32 v34, v34, s65, -v1
    v_exp_f32 v33, v33
    v_exp_f32 v34, v34
    v_cvt_pk_bf16_f32 v28, v33, v33
    v_add_f32 v27, v27, v33
    v_and_b32 v16, v28, v4
    v_and_b32 v17, v28, v5
    v_and_b32 v18, v28, v6
    v_and_b32 v19, v28, v7
    s_waitcnt vmcnt(3)
    buffer_load_dwordx4 v[52:55], v24, s[36:39], s60 offen nt
    s_addk_i32 s60, 0x2000
    v_mfma_f32_16x16x32_bf16 v[12:15], v[152:155], v[16:19], v[12:15]
    v_cvt_pk_bf16_f32 v28, v34, v34
    v_add_f32 v27, v27, v34
    v_and_b32 v20, v28, v4
    v_and_b32 v21, v28, v5
    v_and_b32 v22, v28, v6
    v_and_b32 v23, v28, v7
    s_waitcnt vmcnt(3)
    buffer_load_dwordx4 v[56:59], v24, s[36:39], s60 offen nt
    s_addk_i32 s60, 0x2000
    v_mfma_f32_16x16x32_bf16 v[12:15], v[156:159], v[20:23], v[12:15]
    v_lshlrev_b32 v33, 16, v48
    v_and_b32 v34, s66, v48
    v_fma_f32 v33, v33, s65, -v1
    v_fma_f32 v34, v34, s65, -v1
    v_exp_f32 v33, v33
    v_exp_f32 v34, v34
    v_cvt_pk_bf16_f32 v28, v33, v33
    v_add_f32 v27, v27, v33
    v_and_b32 v16, v28, v4
    v_and_b32 v17, v28, v5
    v_and_b32 v18, v28, v6
    v_and_b32 v19, v28, v7
    s_waitcnt vmcnt(3)
    buffer_load_dwordx4 v[60:63], v24, s[36:39], s60 offen nt
    s_addk_i32 s60, 0x2000
    v_mfma_f32_16x16x32_bf16 v[12:15], v[160:163], v[16:19], v[12:15]
    v_cvt_pk_bf16_f32 v28, v34, v34
    v_add_f32 v27, v27, v34
    v_and_b32 v20, v28, v4
    v_and_b32 v21, v28, v5
    v_and_b32 v22, v28, v6
    v_and_b32 v23, v28, v7
    s_waitcnt vmcnt(3)
    buffer_load_dwordx4 v[64:67], v24, s[36:39], s60 offen nt
    s_addk_i32 s60, 0x2000
    v_mfma_f32_16x16x32_bf16 v[12:15], v[164:167], v[20:23], v[12:15]
    v_lshlrev_b32 v33, 16, v49
    v_and_b32 v34, s66, v49
    v_fma_f32 v33, v33, s65, -v1
    v_fma_f32 v34, v34, s65, -v1
    v_exp_f32 v33, v33
    v_exp_f32 v34, v34
    v_cvt_pk_bf16_f32 v28, v33, v33
    v_add_f32 v27, v27, v33
    v_and_b32 v16, v28, v4
    v_and_b32 v17, v28, v5
    v_and_b32 v18, v28, v6
    v_and_b32 v19, v28, v7
    s_waitcnt vmcnt(3)
    buffer_load_dwordx4 v[68:71], v24, s[36:39], s60 offen nt
    s_addk_i32 s60, 0x2000
    v_mfma_f32_16x16x32_bf16 v[12:15], v[52:55], v[16:19], v[12:15]
    v_cvt_pk_bf16_f32 v28, v34, v34
    v_add_f32 v27, v27, v34
    v_and_b32 v20, v28, v4
    v_and_b32 v21, v28, v5
    v_and_b32 v22, v28, v6
    v_and_b32 v23, v28, v7
    s_waitcnt vmcnt(3)
    buffer_load_dwordx4 v[72:75], v24, s[36:39], s60 offen nt
    s_addk_i32 s60, 0x2000
    v_mfma_f32_16x16x32_bf16 v[12:15], v[56:59], v[20:23], v[12:15]
    v_lshlrev_b32 v33, 16, v50
    v_and_b32 v34, s66, v50
    v_fma_f32 v33, v33, s65, -v1
    v_fma_f32 v34, v34, s65, -v1
    v_exp_f32 v33, v33
    v_exp_f32 v34, v34
    v_cvt_pk_bf16_f32 v28, v33, v33
    v_add_f32 v27, v27, v33
    v_and_b32 v16, v28, v4
    v_and_b32 v17, v28, v5
    v_and_b32 v18, v28, v6
    v_and_b32 v19, v28, v7
    s_barrier
    buffer_load_dword v48, v36, s[40:43], 0 offen
    buffer_load_dwordx4 v[76:79], v2, s[52:55], 0 offen offset:0 nt
    buffer_load_dwordx4 v[80:83], v2, s[52:55], 0 offen offset:2304 nt
    buffer_load_dwordx4 v[84:87], v2, s[52:55], s76 offen offset:0 nt
    buffer_load_dwordx4 v[88:91], v2, s[52:55], s76 offen offset:2304 nt
    buffer_load_dwordx4 v[92:95], v2, s[52:55], s63 offen offset:0 nt
    buffer_load_dwordx4 v[96:99], v2, s[52:55], s63 offen offset:2304 nt
    buffer_load_dwordx4 v[100:103], v2, s[52:55], s77 offen offset:0 nt
    buffer_load_dwordx4 v[104:107], v2, s[52:55], s77 offen offset:2304 nt
    s_waitcnt vmcnt(12)
    v_mfma_f32_16x16x32_bf16 v[12:15], v[60:63], v[16:19], v[12:15]
    v_cvt_pk_bf16_f32 v28, v34, v34
    v_add_f32 v27, v27, v34
    v_and_b32 v20, v28, v4
    v_and_b32 v21, v28, v5
    v_and_b32 v22, v28, v6
    v_and_b32 v23, v28, v7
    s_waitcnt vmcnt(11)
    s_nop 0
    v_mfma_f32_16x16x32_bf16 v[12:15], v[64:67], v[20:23], v[12:15]
    v_lshlrev_b32 v33, 16, v51
    v_and_b32 v34, s66, v51
    v_fma_f32 v33, v33, s65, -v1
    v_fma_f32 v34, v34, s65, -v1
    v_exp_f32 v33, v33
    v_exp_f32 v34, v34
    v_cvt_pk_bf16_f32 v28, v33, v33
    v_add_f32 v27, v27, v33
    v_and_b32 v16, v28, v4
    v_and_b32 v17, v28, v5
    v_and_b32 v18, v28, v6
    v_and_b32 v19, v28, v7
    s_waitcnt vmcnt(10)
    s_nop 0
    v_mfma_f32_16x16x32_bf16 v[12:15], v[68:71], v[16:19], v[12:15]
    v_cvt_pk_bf16_f32 v28, v34, v34
    v_add_f32 v27, v27, v34
    v_and_b32 v20, v28, v4
    v_and_b32 v21, v28, v5
    v_and_b32 v22, v28, v6
    v_and_b32 v23, v28, v7
    v_mov_b32 v28, v27
    s_nop 1
    v_permlane16_swap_b32 v27, v28
    v_add_f32 v27, v27, v28
    v_mov_b32 v28, v27
    s_nop 1
    v_permlane32_swap_b32 v27, v28
    v_add_f32 v27, v27, v28
    s_lshl_b32 s3, s28, 2
    v_mov_b32 v28, s3
    ds_write_b32 v28, v27 offset:160
    s_waitcnt vmcnt(9)
    v_mfma_f32_16x16x32_bf16 v[12:15], v[72:75], v[20:23], v[12:15]
    s_mov_b32 exec_lo, 0xff00ff
    s_mov_b32 exec_hi, 0xff00ff
    s_nop 5
    ds_write_b128 v25, v[12:15]
    s_mov_b64 exec, -1
    s_waitcnt lgkmcnt(0)
    s_barrier
    v_mov_b32 v28, 0
    ds_read_b32 v28, v28 offset:196
    s_waitcnt lgkmcnt(0)
    v_readfirstlane_b32 s61, v28
    s_barrier
    s_mov_b32 s42, s14
    buffer_load_dword v47, v36, s[40:43], 0 offen
    s_branch L_tail
L_helper:
    s_setprio 3
    s_mov_b32 s28, 8
    s_lshl_b32 s63, s29, 8
    s_sub_u32 s42, 4718592, s63
    s_mov_b32 s43, 0x20000
    v_lshrrev_b32 v29, 4, v0
    v_mul_u32_u24 v30, 18, v29
    s_mul_i32 s3, s30, 72
    v_add_u32 v30, s3, v30
    v_and_b32 v31, 0xf0, v28
    v_lshl_add_u32 v25, v30, 13, v31
    v_lshlrev_b32 v30, 1, v30
    s_mov_b32 s61, 0
    s_waitcnt lgkmcnt(0)
    s_mov_b32 s44, s4
    s_mov_b32 s45, s5
    s_add_u32 s40, s10, s63
    s_addc_u32 s41, s11, 0
    buffer_load_dwordx4 v[52:55], v28, s[44:47], 0 offen
    buffer_load_dwordx4 v[56:59], v28, s[44:47], 0 offen offset:1024
    buffer_load_dwordx4 v[36:39], v30, s[44:47], 0 offen
    buffer_load_dwordx4 v[40:43], v30, s[44:47], 0 offen offset:16
    buffer_load_dword v44, v30, s[44:47], 0 offen offset:32
    buffer_load_dwordx4 v[60:63], v25, s[40:43], s61 offen nt
    s_addk_i32 s61, 0x2000
    buffer_load_dwordx4 v[64:67], v25, s[40:43], s61 offen nt
    s_addk_i32 s61, 0x2000
    buffer_load_dwordx4 v[68:71], v25, s[40:43], s61 offen nt
    s_addk_i32 s61, 0x2000
    buffer_load_dwordx4 v[72:75], v25, s[40:43], s61 offen nt
    s_addk_i32 s61, 0x2000
    buffer_load_dwordx4 v[76:79], v25, s[40:43], s61 offen nt
    s_addk_i32 s61, 0x2000
    buffer_load_dwordx4 v[80:83], v25, s[40:43], s61 offen nt
    s_addk_i32 s61, 0x2000
    buffer_load_dwordx4 v[84:87], v25, s[40:43], s61 offen nt
    s_addk_i32 s61, 0x2000
    buffer_load_dwordx4 v[88:91], v25, s[40:43], s61 offen nt
    s_addk_i32 s61, 0x2000
    buffer_load_dwordx4 v[92:95], v25, s[40:43], s61 offen nt
    s_addk_i32 s61, 0x2000
    buffer_load_dwordx4 v[96:99], v25, s[40:43], s61 offen nt
    s_addk_i32 s61, 0x2000
    buffer_load_dwordx4 v[100:103], v25, s[40:43], s61 offen nt
    s_addk_i32 s61, 0x2000
    buffer_load_dwordx4 v[104:107], v25, s[40:43], s61 offen nt
    s_addk_i32 s61, 0x2000
    buffer_load_dwordx4 v[108:111], v25, s[40:43], s61 offen nt
    s_addk_i32 s61, 0x2000
    buffer_load_dwordx4 v[112:115], v25, s[40:43], s61 offen nt
    s_addk_i32 s61, 0x2000
    buffer_load_dwordx4 v[116:119], v25, s[40:43], s61 offen nt
    s_addk_i32 s61, 0x2000
    buffer_load_dwordx4 v[120:123], v25, s[40:43], s61 offen nt
    s_addk_i32 s61, 0x2000
    buffer_load_dwordx4 v[124:127], v25, s[40:43], s61 offen nt
    s_addk_i32 s61, 0x2000
    buffer_load_dwordx4 v[128:131], v25, s[40:43], s61 offen nt
    s_addk_i32 s61, 0x2000
    s_load_dword s71, s[26:27], 0
    s_mov_b32 s44, s4
    s_mov_b32 s45, s5
    s_mov_b32 s43, 0x20000
    s_mov_b32 s48, s26
    s_mov_b32 s49, s27
    s_mov_b32 s50, 0x400000
    s_mov_b32 s51, 0x20000
    s_mov_b32 s56, s22
    s_mov_b32 s57, s23
    s_movk_i32 s58, 1152
    s_mov_b32 s59, 0x20000
    s_mov_b32 s64, 0x3db504f3
    s_mov_b32 s65, 0x3fb8aa3b
    s_mov_b32 s66, 0xffff0000
    s_mov_b32 s67, 0xfffff000
    s_movk_i32 s68, 0xfff
    v_and_b32 v32, 1, v0
    v_lshlrev_b32 v32, 4, v32
    v_mov_b32 v33, 0xffff
    v_lshlrev_b32 v33, v32, v33
    v_bfe_u32 v32, v0, 1, 2
    v_cmp_eq_u32 vcc, 0, v32
    s_nop 1
    v_cndmask_b32 v4, 0, v33, vcc
    v_cmp_eq_u32 vcc, 1, v32
    s_nop 1
    v_cndmask_b32 v5, 0, v33, vcc
    v_cmp_eq_u32 vcc, 2, v32
    s_nop 1
    v_cndmask_b32 v6, 0, v33, vcc
    v_cmp_eq_u32 vcc, 3, v32
    s_nop 1
    v_cndmask_b32 v7, 0, v33, vcc
    s_lshr_b32 s24, s2, 3
    s_lshr_b32 s3, s2, 5
    s_and_b32 s78, s24, 3
    s_cmp_gt_u32 s78, 1
    s_cselect_b32 s62, 1, 0
    s_sub_u32 s62, s78, s62
    s_lshl_b32 s62, s62, 3
    s_add_u32 s62, s62, s3
    s_add_u32 s62, s62, 3
    s_add_u32 s24, s3, 24
    s_cmp_lt_u32 s3, 3
    s_cselect_b32 s24, s3, s24
    s_cmp_eq_u32 s78, 1
    s_cselect_b32 s24, s24, s62
    s_and_b32 s3, s2, 7
    s_mul_i32 s78, s3, 18
    s_add_u32 s78, s78, s24
    s_lshl_b32 s62, s24, 3
    s_add_u32 s62, s62, s3
    s_cmp_lt_u32 s24, 18
    s_cselect_b32 s79, s78, s62
    s_mov_b32 s55, 0x20000
    s_cmp_lt_u32 s79, 144
    s_cbranch_scc0 L_r1_2
    s_mov_b32 s69, s79
    s_mul_i32 s3, s69, 36864
    s_add_u32 s52, s20, s3
    s_addc_u32 s53, s21, 0
    s_mov_b32 s54, 0
    s_mov_b32 s63, 0x40000000
    s_lshl_b32 s3, s28, 7
    s_branch L_r2_2
L_r1_2:
    s_sub_u32 s69, s79, 144
    s_lshr_b32 s69, s69, 3
    s_and_b32 s3, s79, 7
    s_mul_i32 s3, s3, 589824
    s_lshl_b32 s62, s69, 7
    s_sub_u32 s54, 589824, s62
    s_add_u32 s3, s3, s62
    s_cmp_lt_u32 s79, 216
    s_cselect_b32 s54, s54, 0
    s_cselect_b32 s3, s3, 0
    s_add_u32 s52, s12, s3
    s_addc_u32 s53, s13, 0
    s_mov_b32 s63, 36864
    s_mul_i32 s3, s28, 73728
L_r2_2:
    s_movk_i32 s76, 4608
    s_add_u32 s77, s63, s76
    v_lshrrev_b32 v32, 4, v0
    v_bfe_u32 v33, v0, 3, 1
    v_lshl_add_u32 v32, v32, 3, v33
    v_mul_u32_u24 v32, 1152, v32
    v_and_b32 v33, 7, v0
    v_lshl_add_u32 v32, v33, 4, v32
    v_add_u32 v2, s3, v32
    s_mov_b32 s35, 0x20000
    s_mov_b32 s39, 0x20000
    v_mov_b32 v16, 0
    v_lshlrev_b32 v29, 2, v0
    ds_write_b32 v29, v16 offset:0
    v_mov_b32 v24, v28
    s_waitcnt vmcnt(18)
    v_lshlrev_b32 v16, 16, v52
    v_and_b32 v17, s66, v52
    v_lshlrev_b32 v18, 16, v53
    v_and_b32 v19, s66, v53
    v_lshlrev_b32 v20, 16, v54
    v_and_b32 v21, s66, v54
    v_lshlrev_b32 v22, 16, v55
    v_and_b32 v23, s66, v55
    v_lshlrev_b32 v52, 16, v56
    v_lshlrev_b32 v54, 16, v57
    v_lshlrev_b32 v8, 16, v58
    v_lshlrev_b32 v10, 16, v59
    v_and_b32 v53, s66, v56
    v_and_b32 v55, s66, v57
    v_and_b32 v9, s66, v58
    v_and_b32 v11, s66, v59
    v_add_f32 v28, v16, v17
    v_add_f32 v28, v28, v18
    v_add_f32 v28, v28, v19
    v_add_f32 v28, v28, v20
    v_add_f32 v28, v28, v21
    v_add_f32 v28, v28, v22
    v_add_f32 v28, v28, v23
    v_add_f32 v28, v28, v52
    v_add_f32 v28, v28, v53
    v_add_f32 v28, v28, v54
    v_add_f32 v28, v28, v55
    v_add_f32 v28, v28, v8
    v_add_f32 v28, v28, v9
    v_add_f32 v28, v28, v10
    v_add_f32 v28, v28, v11
    s_nop 1
    v_add_f32_dpp v28, v28, v28 row_ror:8 row_mask:0xf bank_mask:0xf
    s_nop 1
    v_add_f32_dpp v28, v28, v28 row_ror:4 row_mask:0xf bank_mask:0xf
    s_nop 1
    v_add_f32_dpp v28, v28, v28 row_ror:2 row_mask:0xf bank_mask:0xf
    s_nop 1
    v_add_f32_dpp v28, v28, v28 row_ror:1 row_mask:0xf bank_mask:0xf
    v_mov_b32 v29, v28
    s_nop 1
    v_permlane16_swap_b32 v28, v29
    v_add_f32 v28, v28, v29
    v_mov_b32 v29, v28
    s_nop 1
    v_permlane32_swap_b32 v28, v29
    v_add_f32 v28, v28, v29
    v_mul_f32 v28, 0x3ae38e39, v28
    v_sub_f32 v16, v16, v28
    v_sub_f32 v17, v17, v28
    v_sub_f32 v18, v18, v28
    v_sub_f32 v19, v19, v28
    v_sub_f32 v20, v20, v28
    v_sub_f32 v21, v21, v28
    v_sub_f32 v22, v22, v28
    v_sub_f32 v23, v23, v28
    v_mul_f32 v30, v16, v16
    v_fmac_f32 v30, v17, v17
    v_fmac_f32 v30, v18, v18
    v_fmac_f32 v30, v19, v19
    v_fmac_f32 v30, v20, v20
    v_fmac_f32 v30, v21, v21
    v_fmac_f32 v30, v22, v22
    v_fmac_f32 v30, v23, v23
    s_mov_b64 exec, 0xff
    v_sub_f32 v52, v52, v28
    v_sub_f32 v53, v53, v28
    v_sub_f32 v54, v54, v28
    v_sub_f32 v55, v55, v28
    v_sub_f32 v8, v8, v28
    v_sub_f32 v9, v9, v28
    v_sub_f32 v10, v10, v28
    v_sub_f32 v11, v11, v28
    v_fmac_f32 v30, v52, v52
    v_fmac_f32 v30, v53, v53
    v_fmac_f32 v30, v54, v54
    v_fmac_f32 v30, v55, v55
    v_fmac_f32 v30, v8, v8
    v_fmac_f32 v30, v9, v9
    v_fmac_f32 v30, v10, v10
    v_fmac_f32 v30, v11, v11
    s_mov_b64 exec, -1
    s_nop 0
    v_add_f32_dpp v30, v30, v30 row_ror:8 row_mask:0xf bank_mask:0xf
    s_nop 1
    v_add_f32_dpp v30, v30, v30 row_ror:4 row_mask:0xf bank_mask:0xf
    s_nop 1
    v_add_f32_dpp v30, v30, v30 row_ror:2 row_mask:0xf bank_mask:0xf
    s_nop 1
    v_add_f32_dpp v30, v30, v30 row_ror:1 row_mask:0xf bank_mask:0xf
    v_mov_b32 v29, v30
    s_nop 1
    v_permlane16_swap_b32 v30, v29
    v_add_f32 v30, v30, v29
    v_mov_b32 v29, v30
    s_nop 1
    v_permlane32_swap_b32 v30, v29
    v_add_f32 v30, v30, v29
    v_mul_f32 v30, 0x3ae38e39, v30
    v_cvt_pk_bf16_f32 v28, v28, v28
    v_and_b32 v28, s66, v28
    v_cvt_pk_bf16_f32 v30, v30, v30
    v_and_b32 v30, s66, v30
    v_add_f32 v30, 0x3727c5ac, v30
    v_cvt_pk_bf16_f32 v30, v30, v30
    v_and_b32 v30, s66, v30
    v_sqrt_f32 v30, v30
    s_nop 0
    v_cvt_pk_bf16_f32 v30, v30, v30
    v_and_b32 v30, s66, v30
    v_rcp_f32 v30, v30
    v_lshlrev_b32 v31, 16, v36
    v_and_b32 v32, s66, v36
    v_sub_f32 v31, v31, v28
    v_sub_f32 v32, v32, v28
    v_cvt_pk_bf16_f32 v36, v31, v32
    v_lshlrev_b32 v31, 16, v36
    v_and_b32 v32, s66, v36
    v_mul_f32 v31, v31, v30
    v_mul_f32 v32, v32, v30
    v_cvt_pk_bf16_f32 v36, v31, v32
    v_lshlrev_b32 v31, 16, v37
    v_and_b32 v32, s66, v37
    v_sub_f32 v31, v31, v28
    v_sub_f32 v32, v32, v28
    v_cvt_pk_bf16_f32 v37, v31, v32
    v_lshlrev_b32 v31, 16, v37
    v_and_b32 v32, s66, v37
    v_mul_f32 v31, v31, v30
    v_mul_f32 v32, v32, v30
    v_cvt_pk_bf16_f32 v37, v31, v32
    v_lshlrev_b32 v31, 16, v38
    v_and_b32 v32, s66, v38
    v_sub_f32 v31, v31, v28
    v_sub_f32 v32, v32, v28
    v_cvt_pk_bf16_f32 v38, v31, v32
    v_lshlrev_b32 v31, 16, v38
    v_and_b32 v32, s66, v38
    v_mul_f32 v31, v31, v30
    v_mul_f32 v32, v32, v30
    v_cvt_pk_bf16_f32 v38, v31, v32
    v_lshlrev_b32 v31, 16, v39
    v_and_b32 v32, s66, v39
    v_sub_f32 v31, v31, v28
    v_sub_f32 v32, v32, v28
    v_cvt_pk_bf16_f32 v39, v31, v32
    v_lshlrev_b32 v31, 16, v39
    v_and_b32 v32, s66, v39
    v_mul_f32 v31, v31, v30
    v_mul_f32 v32, v32, v30
    v_cvt_pk_bf16_f32 v39, v31, v32
    v_lshlrev_b32 v31, 16, v40
    v_and_b32 v32, s66, v40
    v_sub_f32 v31, v31, v28
    v_sub_f32 v32, v32, v28
    v_cvt_pk_bf16_f32 v40, v31, v32
    v_lshlrev_b32 v31, 16, v40
    v_and_b32 v32, s66, v40
    v_mul_f32 v31, v31, v30
    v_mul_f32 v32, v32, v30
    v_cvt_pk_bf16_f32 v40, v31, v32
    v_lshlrev_b32 v31, 16, v41
    v_and_b32 v32, s66, v41
    v_sub_f32 v31, v31, v28
    v_sub_f32 v32, v32, v28
    v_cvt_pk_bf16_f32 v41, v31, v32
    v_lshlrev_b32 v31, 16, v41
    v_and_b32 v32, s66, v41
    v_mul_f32 v31, v31, v30
    v_mul_f32 v32, v32, v30
    v_cvt_pk_bf16_f32 v41, v31, v32
    v_lshlrev_b32 v31, 16, v42
    v_and_b32 v32, s66, v42
    v_sub_f32 v31, v31, v28
    v_sub_f32 v32, v32, v28
    v_cvt_pk_bf16_f32 v42, v31, v32
    v_lshlrev_b32 v31, 16, v42
    v_and_b32 v32, s66, v42
    v_mul_f32 v31, v31, v30
    v_mul_f32 v32, v32, v30
    v_cvt_pk_bf16_f32 v42, v31, v32
    v_lshlrev_b32 v31, 16, v43
    v_and_b32 v32, s66, v43
    v_sub_f32 v31, v31, v28
    v_sub_f32 v32, v32, v28
    v_cvt_pk_bf16_f32 v43, v31, v32
    v_lshlrev_b32 v31, 16, v43
    v_and_b32 v32, s66, v43
    v_mul_f32 v31, v31, v30
    v_mul_f32 v32, v32, v30
    v_cvt_pk_bf16_f32 v43, v31, v32
    v_lshlrev_b32 v31, 16, v44
    v_and_b32 v32, s66, v44
    v_sub_f32 v31, v31, v28
    v_sub_f32 v32, v32, v28
    v_cvt_pk_bf16_f32 v44, v31, v32
    v_lshlrev_b32 v31, 16, v44
    v_and_b32 v32, s66, v44
    v_mul_f32 v31, v31, v30
    v_mul_f32 v32, v32, v30
    v_cvt_pk_bf16_f32 v44, v31, v32
    s_mov_b32 s72, 0x01000100
    s_mov_b32 s73, 0x03020302
    s_waitcnt lgkmcnt(0)
    s_add_u32 s71, s71, 1
    s_and_b32 s31, s71, 0xfff
    v_mov_b32 v3, s31
    s_lshl_b32 s3, s29, 13
    s_add_u32 s3, s3, 655360
    v_add_u32 v27, s3, v24
    s_lshl_b32 s62, s30, 10
    s_mov_b32 s74, 0xff00ff00
    s_mov_b32 s75, 0xff00ff00
    v_perm_b32 v28, v36, v36, s72
    v_and_b32 v16, v28, v4
    v_and_b32 v17, v28, v5
    v_and_b32 v18, v28, v6
    v_and_b32 v19, v28, v7
    s_waitcnt vmcnt(17)
    s_nop 0
    v_mfma_f32_16x16x32_bf16 v[12:15], v[60:63], v[16:19], 0
    v_perm_b32 v28, v36, v36, s73
    v_and_b32 v20, v28, v4
    v_and_b32 v21, v28, v5
    v_and_b32 v22, v28, v6
    v_and_b32 v23, v28, v7
    s_waitcnt vmcnt(16)
    s_nop 0
    v_mfma_f32_16x16x32_bf16 v[12:15], v[64:67], v[20:23], v[12:15]
    v_perm_b32 v28, v37, v37, s72
    v_and_b32 v16, v28, v4
    v_and_b32 v17, v28, v5
    v_and_b32 v18, v28, v6
    v_and_b32 v19, v28, v7
    s_waitcnt vmcnt(15)
    s_nop 0
    v_mfma_f32_16x16x32_bf16 v[12:15], v[68:71], v[16:19], v[12:15]
    v_perm_b32 v28, v37, v37, s73
    v_and_b32 v20, v28, v4
    v_and_b32 v21, v28, v5
    v_and_b32 v22, v28, v6
    v_and_b32 v23, v28, v7
    s_waitcnt vmcnt(14)
    s_nop 0
    v_mfma_f32_16x16x32_bf16 v[12:15], v[72:75], v[20:23], v[12:15]
    v_perm_b32 v28, v38, v38, s72
    v_and_b32 v16, v28, v4
    v_and_b32 v17, v28, v5
    v_and_b32 v18, v28, v6
    v_and_b32 v19, v28, v7
    s_waitcnt vmcnt(13)
    s_nop 0
    v_mfma_f32_16x16x32_bf16 v[12:15], v[76:79], v[16:19], v[12:15]
    v_perm_b32 v28, v38, v38, s73
    v_and_b32 v20, v28, v4
    v_and_b32 v21, v28, v5
    v_and_b32 v22, v28, v6
    v_and_b32 v23, v28, v7
    s_waitcnt vmcnt(12)
    s_nop 0
    v_mfma_f32_16x16x32_bf16 v[12:15], v[80:83], v[20:23], v[12:15]
    v_perm_b32 v28, v39, v39, s72
    v_and_b32 v16, v28, v4
    v_and_b32 v17, v28, v5
    v_and_b32 v18, v28, v6
    v_and_b32 v19, v28, v7
    s_waitcnt vmcnt(11)
    s_nop 0
    v_mfma_f32_16x16x32_bf16 v[12:15], v[84:87], v[16:19], v[12:15]
    v_perm_b32 v28, v39, v39, s73
    v_and_b32 v20, v28, v4
    v_and_b32 v21, v28, v5
    v_and_b32 v22, v28, v6
    v_and_b32 v23, v28, v7
    s_waitcnt vmcnt(10)
    s_nop 0
    v_mfma_f32_16x16x32_bf16 v[12:15], v[88:91], v[20:23], v[12:15]
    v_perm_b32 v28, v40, v40, s72
    v_and_b32 v16, v28, v4
    v_and_b32 v17, v28, v5
    v_and_b32 v18, v28, v6
    v_and_b32 v19, v28, v7
    s_waitcnt vmcnt(9)
    s_nop 0
    v_mfma_f32_16x16x32_bf16 v[12:15], v[92:95], v[16:19], v[12:15]
    v_perm_b32 v28, v40, v40, s73
    v_and_b32 v20, v28, v4
    v_and_b32 v21, v28, v5
    v_and_b32 v22, v28, v6
    v_and_b32 v23, v28, v7
    s_waitcnt vmcnt(8)
    s_nop 0
    v_mfma_f32_16x16x32_bf16 v[12:15], v[96:99], v[20:23], v[12:15]
    v_perm_b32 v28, v41, v41, s72
    v_and_b32 v16, v28, v4
    v_and_b32 v17, v28, v5
    v_and_b32 v18, v28, v6
    v_and_b32 v19, v28, v7
    s_waitcnt vmcnt(7)
    s_nop 0
    v_mfma_f32_16x16x32_bf16 v[12:15], v[100:103], v[16:19], v[12:15]
    v_perm_b32 v28, v41, v41, s73
    v_and_b32 v20, v28, v4
    v_and_b32 v21, v28, v5
    v_and_b32 v22, v28, v6
    v_and_b32 v23, v28, v7
    s_waitcnt vmcnt(6)
    s_nop 0
    v_mfma_f32_16x16x32_bf16 v[12:15], v[104:107], v[20:23], v[12:15]
    v_perm_b32 v28, v42, v42, s72
    v_and_b32 v16, v28, v4
    v_and_b32 v17, v28, v5
    v_and_b32 v18, v28, v6
    v_and_b32 v19, v28, v7
    s_waitcnt vmcnt(5)
    s_nop 0
    v_mfma_f32_16x16x32_bf16 v[12:15], v[108:111], v[16:19], v[12:15]
    v_perm_b32 v28, v42, v42, s73
    v_and_b32 v20, v28, v4
    v_and_b32 v21, v28, v5
    v_and_b32 v22, v28, v6
    v_and_b32 v23, v28, v7
    s_waitcnt vmcnt(4)
    s_nop 0
    v_mfma_f32_16x16x32_bf16 v[12:15], v[112:115], v[20:23], v[12:15]
    v_perm_b32 v28, v43, v43, s72
    v_and_b32 v16, v28, v4
    v_and_b32 v17, v28, v5
    v_and_b32 v18, v28, v6
    v_and_b32 v19, v28, v7
    s_waitcnt vmcnt(3)
    s_nop 0
    v_mfma_f32_16x16x32_bf16 v[12:15], v[116:119], v[16:19], v[12:15]
    v_perm_b32 v28, v43, v43, s73
    v_and_b32 v20, v28, v4
    v_and_b32 v21, v28, v5
    v_and_b32 v22, v28, v6
    v_and_b32 v23, v28, v7
    s_waitcnt vmcnt(2)
    s_nop 0
    v_mfma_f32_16x16x32_bf16 v[12:15], v[120:123], v[20:23], v[12:15]
    v_perm_b32 v28, v44, v44, s72
    v_and_b32 v16, v28, v4
    v_and_b32 v17, v28, v5
    v_and_b32 v18, v28, v6
    v_and_b32 v19, v28, v7
    s_waitcnt vmcnt(1)
    s_nop 0
    v_mfma_f32_16x16x32_bf16 v[12:15], v[124:127], v[16:19], v[12:15]
    v_perm_b32 v28, v44, v44, s73
    v_and_b32 v20, v28, v4
    v_and_b32 v21, v28, v5
    v_and_b32 v22, v28, v6
    v_and_b32 v23, v28, v7
    s_waitcnt vmcnt(0)
    s_nop 0
    v_mfma_f32_16x16x32_bf16 v[12:15], v[128:131], v[20:23], v[12:15]
    v_mov_b32 v17, s71
    v_mov_b32 v19, s71
    s_nop 5
    v_cndmask_b32 v16, v12, v14, s[74:75]
    v_cndmask_b32 v18, v13, v15, s[74:75]
    buffer_store_dwordx4 v[16:19], v27, s[48:51], s62 offen sc1
    s_getreg_b32 s78, hwreg(HW_REG_XCC_ID, 0, 4)
    s_lshl_b32 s3, s71, 4
    s_or_b32 s3, s3, s78
    v_mov_b32 v28, s3
    s_and_b32 s3, s2, 7
    s_lshl_b32 s3, s3, 5
    s_lshr_b32 s62, s2, 3
    s_add_u32 s3, s3, s62
    s_lshl_b32 s3, s3, 2
    s_add_u32 s3, s3, 229376
    v_mov_b32 v29, s3
    s_mov_b64 exec, 1
    buffer_store_dword v28, v29, s[48:51], 0 offen sc1
    s_mov_b64 exec, -1
    s_mov_b32 s61, 2097152
    v_lshrrev_b32 v1, 3, v0
    v_lshlrev_b32 v1, 5, v1
    v_and_b32 v29, 7, v0
    v_lshl_add_u32 v1, v29, 1, v1
    s_mov_b32 s60, 0
    s_add_u32 s62, s60, 0x1000
    s_sleep 32
    s_mov_b32 s70, 0x40000
L_pq:
    buffer_load_dwordx4 v[60:63], v27, s[48:51], s60 offen offset:0 sc1
    buffer_load_dwordx4 v[64:67], v27, s[48:51], s60 offen offset:1024 sc1
    buffer_load_dwordx4 v[68:71], v27, s[48:51], s60 offen offset:2048 sc1
    buffer_load_dwordx4 v[72:75], v27, s[48:51], s60 offen offset:3072 sc1
    buffer_load_dwordx4 v[76:79], v27, s[48:51], s62 offen offset:0 sc1
    buffer_load_dwordx4 v[80:83], v27, s[48:51], s62 offen offset:1024 sc1
    buffer_load_dwordx4 v[84:87], v27, s[48:51], s62 offen offset:2048 sc1
    buffer_load_dwordx4 v[88:91], v27, s[48:51], s62 offen offset:3072 sc1
    s_waitcnt vmcnt(7)
    v_bitop3_b32 v29, v61, v63, s71 bitop3:0x7e
    v_mov_b32 v28, v29
    s_waitcnt vmcnt(6)
    v_bitop3_b32 v29, v65, v67, s71 bitop3:0x7e
    v_or_b32 v28, v28, v29
    s_waitcnt vmcnt(5)
    v_bitop3_b32 v29, v69, v71, s71 bitop3:0x7e
    v_or_b32 v28, v28, v29
    s_waitcnt vmcnt(4)
    v_bitop3_b32 v29, v73, v75, s71 bitop3:0x7e
    v_or_b32 v28, v28, v29
    s_waitcnt vmcnt(3)
    v_bitop3_b32 v29, v77, v79, s71 bitop3:0x7e
    v_or_b32 v28, v28, v29
    s_waitcnt vmcnt(2)
    v_bitop3_b32 v29, v81, v83, s71 bitop3:0x7e
    v_or_b32 v28, v28, v29
    s_waitcnt vmcnt(1)
    v_bitop3_b32 v29, v85, v87, s71 bitop3:0x7e
    v_or_b32 v28, v28, v29
    s_waitcnt vmcnt(0)
    v_bitop3_b32 v29, v89, v91, s71 bitop3:0x7e
    v_or_b32 v28, v28, v29
    v_cmp_ne_u32 vcc, 0, v28
    s_cbranch_vccz L_pq_ok
    s_sub_u32 s70, s70, 1
    s_cmp_lg_u32 s70, 0
    s_cbranch_scc1 L_pq
L_pq_ok:
    v_add_f32 v60, v60, v64
    v_add_f32 v62, v62, v66
    v_add_f32 v60, v60, v68
    v_add_f32 v62, v62, v70
    v_add_f32 v60, v60, v72
    v_add_f32 v62, v62, v74
    v_add_f32 v60, v60, v76
    v_add_f32 v62, v62, v78
    v_add_f32 v60, v60, v80
    v_add_f32 v62, v62, v82
    v_add_f32 v60, v60, v84
    v_add_f32 v62, v62, v86
    v_add_f32 v60, v60, v88
    v_add_f32 v62, v62, v90
    v_cvt_pk_bf16_f32 v60, v60, v62
    ds_write_b16 v1, v60 offset:256
    ds_write_b16_d16_hi v1, v60 offset:272
    s_waitcnt lgkmcnt(0)
    s_barrier
    v_mov_b32 v28, v24
    s_lshl_b32 s3, s29, 3
    s_add_u32 s3, s3, s30
    s_lshl_b32 s62, s3, 9
    s_add_u32 s62, s62, 65536
    v_add_u32 v25, s62, v28
    s_lshl_b32 s62, s3, 4
    s_add_u32 s62, s62, 196608
    v_writelane_b32 v25, s62, 32
    v_and_b32 v24, 0x1f0, v28
    v_lshrrev_b32 v29, 5, v0
    v_lshl_add_u32 v24, v29, 11, v24
    s_barrier
    s_and_b32 s3, s2, 7
    s_lshl_b32 s3, s3, 7
    s_add_u32 s60, s3, 229376
    v_and_b32 v37, 31, v0
    v_lshlrev_b32 v37, 2, v37
    buffer_load_dword v36, v37, s[48:51], s60 offen sc1
    v_mov_b32 v28, 0
    ds_read_b128 v[8:11], v28 offset:128
    ds_read_b128 v[30:33], v28 offset:144
    s_waitcnt lgkmcnt(0)
    v_max3_f32 v26, v8, v9, v10
    v_max3_f32 v26, v26, v11, v30
    v_max3_f32 v26, v26, v31, v32
    v_max_f32 v26, v26, v33
    s_waitcnt vmcnt(0)
    s_lshl_b32 s3, s71, 4
    s_or_b32 s3, s3, s78
    v_cmp_ne_u32 vcc, s3, v36
    s_cmp_eq_u32 vcc_lo, 0
    s_cselect_b32 s3, 2097152, 0
    v_mov_b32 v28, s3
    v_mov_b32 v1, 0
    ds_write_b32 v1, v28 offset:196
    s_waitcnt lgkmcnt(0)
    v_mov_b32 v1, 0
    s_barrier
    s_barrier
    ds_read_b128 v[108:111], v1 offset:160
    ds_read_b128 v[112:115], v1 offset:176
    ds_read_b128 v[12:15], v24 offset:4096
    ds_read_b128 v[8:11], v24 offset:4608
    ds_read_b128 v[16:19], v24 offset:5120
    ds_read_b128 v[20:23], v24 offset:5632
    s_waitcnt lgkmcnt(2)
    v_pk_add_f32 v[12:13], v[12:13], v[8:9]
    v_pk_add_f32 v[14:15], v[14:15], v[10:11]
    s_waitcnt lgkmcnt(1)
    v_pk_add_f32 v[12:13], v[12:13], v[16:17]
    v_pk_add_f32 v[14:15], v[14:15], v[18:19]
    s_waitcnt lgkmcnt(0)
    v_pk_add_f32 v[12:13], v[12:13], v[20:21]
    v_pk_add_f32 v[14:15], v[14:15], v[22:23]
    v_pk_add_f32 v[108:109], v[108:109], v[112:113]
    v_pk_add_f32 v[110:111], v[110:111], v[114:115]
    v_permlane32_swap_b32 v12, v28
    v_permlane32_swap_b32 v13, v29
    v_permlane32_swap_b32 v14, v30
    v_permlane32_swap_b32 v15, v31
    v_pk_add_f32 v[12:13], v[12:13], v[28:29]
    v_pk_add_f32 v[14:15], v[14:15], v[30:31]
    v_add_f32 v108, v108, v109
    v_add_f32 v110, v110, v111
    s_mov_b32 exec_lo, 0
    s_mov_b32 exec_hi, 1
    v_add_f32 v13, v108, v110
    v_mov_b32 v12, v26
    v_mov_b32 v14, v26
    v_mov_b32 v15, v26
    s_mov_b32 exec_lo, -1
    v_and_or_b32 v12, v12, s67, v3
    v_and_or_b32 v13, v13, s67, v3
    v_and_or_b32 v14, v14, s67, v3
    v_and_or_b32 v15, v15, s67, v3
    buffer_store_dwordx4 v[12:15], v25, s[48:51], s61 offen
    buffer_store_dwordx4 v[12:15], v25, s[48:51], 0 offen sc1
    s_mov_b64 exec, -1
    s_barrier
    s_setprio 0
L_tail:
    s_cmp_lt_u32 s79, 144
    s_cbranch_scc1 L_ffn
    s_cmp_lt_u32 s79, 216
    s_cbranch_scc1 L_wo
    s_and_b32 s3, s2, 7
    s_mul_i32 s3, s3, 663552
    s_sub_u32 s62, s24, 27
    s_mul_i32 s62, s62, 132736
    s_sub_u32 s42, 663552, s62
    s_min_u32 s42, s42, 132736
    s_add_u32 s3, s3, s62
    s_add_u32 s40, s20, s3
    s_addc_u32 s41, s21, 0
    s_lshl_b32 s3, s28, 14
    v_lshl_add_u32 v28, v0, 7, s3
    s_movk_i32 s3, 0x2000
    buffer_load_dword v50, v28, s[40:43], 0 offen
    buffer_load_dword v51, v28, s[40:43], s3 offen
    s_cmp_lt_u32 s79, 252
    s_cbranch_scc1 L_red
    s_branch L_done
L_wo:
    s_cmp_eq_u32 s28, 8
    s_cbranch_scc1 L_wo_pub
    s_and_b32 s3, s79, 7
    s_lshl_b32 s3, s3, 2
    s_lshr_b32 s62, s28, 1
    s_add_u32 s3, s3, s62
    s_lshl_b32 s62, s3, 12
    s_and_b32 s60, s28, 1
    s_lshl_b32 s60, s60, 8
    s_add_u32 s62, s62, s60
    s_add_u32 s62, s62, 65536
    v_lshrrev_b32 v32, 4, v0
    v_and_b32 v33, 15, v0
    v_lshlrev_b32 v24, 9, v32
    v_lshl_add_u32 v24, v33, 4, v24
    v_add_u32 v24, s62, v24
    s_lshl_b32 s62, s3, 7
    s_add_u32 s62, s62, 196608
    v_bfe_u32 v34, v0, 3, 1
    v_lshl_add_u32 v34, v34, 2, v32
    v_lshlrev_b32 v25, 4, v34
    v_add_u32 v25, s62, v25
    s_lshl_b32 s3, s28, 9
    s_add_u32 s3, s3, 4096
    v_lshrrev_b32 v26, 4, v0
    v_lshlrev_b32 v26, 7, v26
    v_and_b32 v35, 7, v0
    v_lshl_add_u32 v26, v35, 4, v26
    v_add_u32 v26, s3, v26
    s_mov_b32 s74, 0xff00ff00
    s_mov_b32 s75, 0xff00ff00
    s_mov_b32 s70, 0x40000
    s_mov_b64 s[4:5], -1
    s_mov_b64 s[6:7], -1
    s_mov_b64 s[8:9], -1
L_p1:
    s_or_b64 exec, s[4:5], 1
    buffer_load_dwordx4 v[120:123], v25, s[48:51], s61 offen sc1
    s_or_b64 exec, s[6:7], 1
    buffer_load_dwordx4 v[124:127], v24, s[48:51], s61 offen sc1
    s_or_b64 exec, s[8:9], 1
    buffer_load_dwordx4 v[128:131], v24, s[48:51], s61 offen offset:2048 sc1
    s_mov_b64 exec, s[4:5]
    s_waitcnt vmcnt(0)
    s_cbranch_execz L_p1_z00
    v_bitop3_b32 v29, v120, v121, s31 bitop3:0x7e
    v_bitop3_b32 v30, v122, v123, s31 bitop3:0x7e
    v_bitop3_b32 v29, v29, v30, s68 bitop3:0xa8
    v_and_b32 v116, s67, v120
    v_and_b32 v117, s67, v121
    v_and_b32 v118, s67, v122
    v_and_b32 v119, s67, v123
    v_cmp_ne_u32 s[4:5], 0, v29
L_p1_z00:
    s_mov_b64 exec, s[6:7]
    s_cbranch_execz L_p1_z01
    v_bitop3_b32 v29, v124, v125, s31 bitop3:0x7e
    v_bitop3_b32 v30, v126, v127, s31 bitop3:0x7e
    v_bitop3_b32 v29, v29, v30, s68 bitop3:0xa8
    v_and_b32 v108, s67, v124
    v_and_b32 v109, s67, v125
    v_and_b32 v110, s67, v126
    v_and_b32 v111, s67, v127
    v_cmp_ne_u32 s[6:7], 0, v29
L_p1_z01:
    s_mov_b64 exec, s[8:9]
    s_cbranch_execz L_p1_z02
    v_bitop3_b32 v29, v128, v129, s31 bitop3:0x7e
    v_bitop3_b32 v30, v130, v131, s31 bitop3:0x7e
    v_bitop3_b32 v29, v29, v30, s68 bitop3:0xa8
    v_and_b32 v112, s67, v128
    v_and_b32 v113, s67, v129
    v_and_b32 v114, s67, v130
    v_and_b32 v115, s67, v131
    v_cmp_ne_u32 s[8:9], 0, v29
L_p1_z02:
    s_or_b64 vcc, s[4:5], s[6:7]
    s_or_b64 vcc, vcc, s[8:9]
    s_cbranch_scc0 L_p1_ok
    s_sub_u32 s70, s70, 1
    s_cmp_lg_u32 s70, 0
    s_cbranch_scc1 L_p1
L_p1_ok:
    s_mov_b64 exec, -1
    v_max_f32_dpp v32, v116, v116 row_ror:8 row_mask:0xf bank_mask:0xf
    v_mov_b32 v33, v32
    s_nop 1
    v_permlane16_swap_b32 v32, v33
    v_max_f32 v32, v32, v33
    v_mov_b32 v33, v32
    s_nop 1
    v_permlane32_swap_b32 v32, v33
    v_max_f32 v32, v32, v33
    v_sub_f32 v116, v116, v32
    v_mul_f32 v116, s65, v116
    v_exp_f32 v116, v116
    s_nop 0
    v_mul_f32 v117, v117, v116
    v_mov_b32_dpp v30, v116 row_ror:8 row_mask:0xf bank_mask:0xf
    s_nop 0
    v_add_f32_dpp v117, v117, v117 row_ror:8 row_mask:0xf bank_mask:0xf
    v_cndmask_b32 v31, v116, v30, s[74:75]
    v_cndmask_b32 v30, v30, v116, s[74:75]
    v_mul_f32 v108, v108, v31
    v_mul_f32 v109, v109, v31
    v_mul_f32 v110, v110, v31
    v_mul_f32 v111, v111, v31
    v_fmac_f32 v108, v112, v30
    v_fmac_f32 v109, v113, v30
    v_fmac_f32 v110, v114, v30
    v_fmac_f32 v111, v115, v30
    v_mov_b32 v33, v117
    v_permlane16_swap_b32 v108, v109
    s_nop 0
    v_permlane16_swap_b32 v117, v33
    v_permlane16_swap_b32 v110, v111
    v_add_f32 v117, v117, v33
    v_add_f32 v108, v108, v109
    v_mov_b32 v33, v117
    v_add_f32 v110, v110, v111
    s_nop 0
    v_permlane32_swap_b32 v117, v33
    v_permlane32_swap_b32 v108, v110
    v_add_f32 v117, v117, v33
    v_add_f32 v108, v108, v110
    v_rcp_f32 v117, v117
    s_nop 0
    v_mul_f32 v108, v108, v117
    v_cvt_pk_bf16_f32 v108, v108, v108
    s_nop 1
    v_mov_b32_dpp v34, v108 row_newbcast:0 row_mask:0xf bank_mask:0x3
    v_mov_b32_dpp v34, v108 row_newbcast:1 row_mask:0xf bank_mask:0xc
    v_and_b32 v16, v34, v4
    v_and_b32 v17, v34, v5
    v_and_b32 v18, v34, v6
    v_and_b32 v19, v34, v7
    v_mov_b32_dpp v35, v108 row_newbcast:2 row_mask:0xf bank_mask:0x3
    v_mov_b32_dpp v35, v108 row_newbcast:3 row_mask:0xf bank_mask:0xc
    v_mfma_f32_16x16x32_bf16 v[12:15], v[76:79], v[16:19], 0
    v_and_b32 v20, v35, v4
    v_and_b32 v21, v35, v5
    v_and_b32 v22, v35, v6
    v_and_b32 v23, v35, v7
    v_mov_b32_dpp v34, v108 row_newbcast:4 row_mask:0xf bank_mask:0x3
    v_mov_b32_dpp v34, v108 row_newbcast:5 row_mask:0xf bank_mask:0xc
    v_mfma_f32_16x16x32_bf16 v[12:15], v[80:83], v[20:23], v[12:15]
    v_and_b32 v16, v34, v4
    v_and_b32 v17, v34, v5
    v_and_b32 v18, v34, v6
    v_and_b32 v19, v34, v7
    v_mov_b32_dpp v35, v108 row_newbcast:6 row_mask:0xf bank_mask:0x3
    v_mov_b32_dpp v35, v108 row_newbcast:7 row_mask:0xf bank_mask:0xc
    v_mfma_f32_16x16x32_bf16 v[12:15], v[84:87], v[16:19], v[12:15]
    v_and_b32 v20, v35, v4
    v_and_b32 v21, v35, v5
    v_and_b32 v22, v35, v6
    v_and_b32 v23, v35, v7
    v_mov_b32_dpp v34, v108 row_newbcast:8 row_mask:0xf bank_mask:0x3
    v_mov_b32_dpp v34, v108 row_newbcast:9 row_mask:0xf bank_mask:0xc
    v_mfma_f32_16x16x32_bf16 v[12:15], v[88:91], v[20:23], v[12:15]
    v_and_b32 v16, v34, v4
    v_and_b32 v17, v34, v5
    v_and_b32 v18, v34, v6
    v_and_b32 v19, v34, v7
    v_mov_b32_dpp v35, v108 row_newbcast:10 row_mask:0xf bank_mask:0x3
    v_mov_b32_dpp v35, v108 row_newbcast:11 row_mask:0xf bank_mask:0xc
    v_mfma_f32_16x16x32_bf16 v[12:15], v[92:95], v[16:19], v[12:15]
    v_and_b32 v20, v35, v4
    v_and_b32 v21, v35, v5
    v_and_b32 v22, v35, v6
    v_and_b32 v23, v35, v7
    v_mov_b32_dpp v34, v108 row_newbcast:12 row_mask:0xf bank_mask:0x3
    v_mov_b32_dpp v34, v108 row_newbcast:13 row_mask:0xf bank_mask:0xc
    v_mfma_f32_16x16x32_bf16 v[12:15], v[96:99], v[20:23], v[12:15]
    v_and_b32 v16, v34, v4
    v_and_b32 v17, v34, v5
    v_and_b32 v18, v34, v6
    v_and_b32 v19, v34, v7
    v_mov_b32_dpp v35, v108 row_newbcast:14 row_mask:0xf bank_mask:0x3
    v_mov_b32_dpp v35, v108 row_newbcast:15 row_mask:0xf bank_mask:0xc
    v_mfma_f32_16x16x32_bf16 v[12:15], v[100:103], v[16:19], v[12:15]
    v_and_b32 v20, v35, v4
    v_and_b32 v21, v35, v5
    v_and_b32 v22, v35, v6
    v_and_b32 v23, v35, v7
    s_nop 1
    v_mfma_f32_16x16x32_bf16 v[12:15], v[104:107], v[20:23], v[12:15]
    s_mov_b32 exec_lo, 0xff00ff
    s_mov_b32 exec_hi, 0xff00ff00
    s_nop 5
    ds_write_b128 v26, v[12:15]
    s_waitcnt lgkmcnt(0)
    s_barrier
    s_branch L_done
L_wo_pub:
    s_and_b32 s3, s79, 7
    s_lshl_b32 s3, s3, 8
    s_lshl_b32 s62, s69, 11
    s_add_u32 s3, s3, s62
    s_add_u32 s3, s3, 1310720
    v_lshrrev_b32 v32, 4, v0
    v_and_b32 v33, 15, v0
    v_lshlrev_b32 v33, 4, v33
    v_lshl_add_u32 v24, v32, 10, v33
    v_lshl_add_u32 v25, v32, 15, v33
    v_add_u32 v25, s3, v25
    s_mov_b32 s62, 131072
    s_barrier
    ds_read_b128 v[12:15], v24 offset:4096
    ds_read_b128 v[8:11], v24 offset:4352
    ds_read_b128 v[16:19], v24 offset:4608
    ds_read_b128 v[20:23], v24 offset:4864
    s_waitcnt lgkmcnt(2)
    v_pk_add_f32 v[12:13], v[12:13], v[8:9]
    v_pk_add_f32 v[14:15], v[14:15], v[10:11]
    s_waitcnt lgkmcnt(1)
    v_pk_add_f32 v[12:13], v[12:13], v[16:17]
    v_pk_add_f32 v[14:15], v[14:15], v[18:19]
    s_waitcnt lgkmcnt(0)
    v_pk_add_f32 v[12:13], v[12:13], v[20:21]
    v_pk_add_f32 v[14:15], v[14:15], v[22:23]
    v_pk_mov_b32 v[28:29], v[12:13], v[12:13] op_sel:[0,1]
    v_pk_mov_b32 v[30:31], v[14:15], v[14:15] op_sel:[0,1]
    s_nop 0
    v_permlane32_swap_b32 v12, v28
    v_permlane32_swap_b32 v13, v29
    v_permlane32_swap_b32 v14, v30
    v_permlane32_swap_b32 v15, v31
    v_pk_add_f32 v[12:13], v[12:13], v[28:29]
    v_pk_add_f32 v[14:15], v[14:15], v[30:31]
    v_pk_mov_b32 v[28:29], v[12:13], v[12:13] op_sel:[0,1]
    v_pk_mov_b32 v[30:31], v[14:15], v[14:15] op_sel:[0,1]
    s_nop 0
    v_permlane16_swap_b32 v12, v28
    v_permlane16_swap_b32 v13, v29
    v_permlane16_swap_b32 v14, v30
    v_permlane16_swap_b32 v15, v31
    v_pk_add_f32 v[12:13], v[12:13], v[28:29]
    v_pk_add_f32 v[14:15], v[14:15], v[30:31]
    v_and_or_b32 v12, v12, s67, v3
    v_and_or_b32 v13, v13, s67, v3
    v_and_or_b32 v14, v14, s67, v3
    v_and_or_b32 v15, v15, s67, v3
    buffer_store_dwordx4 v[12:15], v25, s[48:51], 0 offen sc1
    buffer_store_dwordx4 v[12:15], v25, s[48:51], s62 offen sc1
    s_branch L_done
L_ffn:
    s_mov_b32 s54, 36864
    s_cmp_eq_u32 s28, 0
    s_cselect_b32 s12, 0, 0x40000000
    s_add_u32 s13, s12, s76
    v_lshrrev_b32 v32, 4, v0
    v_bfe_u32 v33, v0, 3, 1
    v_lshl_add_u32 v34, v32, 3, v33
    s_lshl_b32 s3, s28, 6
    v_add_u32 v34, s3, v34
    v_mul_u32_u24 v34, 9216, v34
    v_and_b32 v35, 3, v0
    v_lshl_add_u32 v34, v35, 4, v34
    s_lshl_b32 s62, s69, 6
    v_add_u32 v34, s62, v34
    s_mov_b32 s74, 0xf0f0f0f0
    s_mov_b32 s75, 0xf0f0f0f0
    v_mov_b32 v152, s16
    v_mov_b32 v153, s17
    v_mov_b32 v154, s18
    v_mov_b32 v155, s19
    v_cndmask_b32 v152, v152, v154, s[74:75]
    v_cndmask_b32 v153, v153, v155, s[74:75]
    v_add_co_u32 v152, vcc, v152, v34
    s_nop 1
    v_addc_co_u32 v153, vcc, 0, v153, vcc
    s_movk_i32 s72, 18432
    s_mov_b32 s73, 0
    s_mov_b32 s10, 239616
    s_mov_b32 s11, 0
    global_load_dwordx4 v[108:111], v[152:153], off
    v_lshl_add_u64 v[152:153], s[72:73], 0, v[152:153]
    global_load_dwordx4 v[112:115], v[152:153], off
    v_lshl_add_u64 v[152:153], s[72:73], 0, v[152:153]
    global_load_dwordx4 v[116:119], v[152:153], off
    v_lshl_add_u64 v[152:153], s[72:73], 0, v[152:153]
    global_load_dwordx4 v[120:123], v[152:153], off
    v_lshl_add_u64 v[152:153], s[10:11], 0, v[152:153]
    global_load_dwordx4 v[124:127], v[152:153], off
    v_lshl_add_u64 v[152:153], s[72:73], 0, v[152:153]
    global_load_dwordx4 v[128:131], v[152:153], off
    v_lshl_add_u64 v[152:153], s[72:73], 0, v[152:153]
    global_load_dwordx4 v[132:135], v[152:153], off
    v_lshl_add_u64 v[152:153], s[72:73], 0, v[152:153]
    global_load_dwordx4 v[136:139], v[152:153], off
    v_lshl_add_u32 v27, v33, 2, v32
    v_and_b32 v34, 7, v0
    v_lshl_add_u32 v27, v27, 3, v34
    v_add_u32 v27, s3, v27
    v_lshlrev_b32 v27, 1, v27
    buffer_load_ushort v154, v27, s[44:47], 0 offen
    v_and_b32 v33, 15, v0
    s_lshl_b32 s3, s28, 11
    s_and_b32 s62, s2, 7
    s_lshl_b32 s62, s62, 15
    s_add_u32 s3, s3, s62
    s_add_u32 s3, s3, 1310720
    v_lshlrev_b32 v24, 8, v32
    v_lshl_add_u32 v24, v33, 4, v24
    v_add_u32 v24, s3, v24
    s_lshl_b32 s3, s28, 9
    s_add_u32 s3, s3, 4096
    v_lshrrev_b32 v26, 4, v0
    v_lshlrev_b32 v26, 7, v26
    v_and_b32 v35, 7, v0
    v_lshl_add_u32 v26, v35, 4, v26
    v_add_u32 v26, s3, v26
    v_bfe_u32 v25, v0, 4, 1
    v_lshlrev_b32 v25, 2, v25
    s_lshl_b32 s3, s28, 3
    v_add_u32 v25, s3, v25
    v_and_b32 v44, 31, v0
    v_lshlrev_b32 v44, 4, v44
    v_lshrrev_b32 v37, 5, v0
    v_lshl_add_u32 v37, v37, 11, v44
    s_lshl_b32 s3, s69, 6
    s_mul_i32 s62, s28, 36864
    s_add_u32 s3, s3, s62
    s_add_u32 s3, s3, 262144
    v_bfe_u32 v38, v0, 2, 1
    v_lshl_add_u32 v38, v32, 1, v38
    v_mul_u32_u24 v38, 9216, v38
    v_and_b32 v35, 3, v0
    v_lshl_add_u32 v38, v35, 4, v38
    v_add_u32 v38, s3, v38
    s_mov_b32 s10, 0.5
    s_mov_b32 s11, 0.5
    v_lshlrev_b32 v39, 3, v33
    s_lshl_b32 s3, s28, 8
    s_add_u32 s3, s3, 512
    v_and_b32 v45, 1, v0
    v_lshl_add_u32 v45, v32, 1, v45
    v_lshlrev_b32 v45, 5, v45
    v_bfe_u32 v35, v0, 1, 3
    v_lshl_add_u32 v45, v35, 2, v45
    v_add_u32 v45, s3, v45
    v_lshrrev_b32 v46, 3, v0
    v_lshl_add_u32 v46, v46, 5, s3
    s_mov_b32 s70, 0x40000
    s_mov_b64 s[4:5], -1
    s_mov_b64 s[6:7], -1
    buffer_load_dwordx4 v[156:159], v24, s[48:51], 0 offen offset:0 sc1
    buffer_load_dwordx4 v[160:163], v24, s[48:51], 0 offen offset:1024 sc1
    v_mov_b32 v28, 0x3f803f80
    v_and_b32 v16, v28, v4
    v_and_b32 v17, v28, v5
    v_and_b32 v18, v28, v6
    v_and_b32 v19, v28, v7
    s_waitcnt vmcnt(10)
    s_nop 0
    v_mfma_f32_16x16x32_bf16 v[8:11], v[108:111], v[16:19], 0
    s_waitcnt vmcnt(9)
    v_mfma_f32_16x16x32_bf16 v[8:11], v[112:115], v[16:19], v[8:11]
    s_waitcnt vmcnt(8)
    v_mfma_f32_16x16x32_bf16 v[8:11], v[116:119], v[16:19], v[8:11]
    s_waitcnt vmcnt(7)
    v_mfma_f32_16x16x32_bf16 v[8:11], v[120:123], v[16:19], v[8:11]
    s_waitcnt vmcnt(6)
    v_mfma_f32_16x16x32_bf16 v[8:11], v[124:127], v[16:19], v[8:11]
    s_waitcnt vmcnt(5)
    v_mfma_f32_16x16x32_bf16 v[8:11], v[128:131], v[16:19], v[8:11]
    s_waitcnt vmcnt(4)
    v_mfma_f32_16x16x32_bf16 v[8:11], v[132:135], v[16:19], v[8:11]
    s_waitcnt vmcnt(3)
    v_mfma_f32_16x16x32_bf16 v[8:11], v[136:139], v[16:19], v[8:11]
    s_nop 7
    v_permlane32_swap_b32 v8, v20
    v_permlane32_swap_b32 v9, v21
    v_permlane32_swap_b32 v10, v22
    v_permlane32_swap_b32 v11, v23
    v_add_f32_dpp v40, v20, v8 row_ror:8 row_mask:0xf bank_mask:0xf
    v_add_f32_dpp v41, v21, v9 row_ror:8 row_mask:0xf bank_mask:0xf
    v_add_f32_dpp v42, v22, v10 row_ror:8 row_mask:0xf bank_mask:0xf
    v_add_f32_dpp v43, v23, v11 row_ror:8 row_mask:0xf bank_mask:0xf
    s_branch L_p2_chk
L_p2_re:
L_p2:
    s_or_b64 exec, s[4:5], 1
    buffer_load_dwordx4 v[156:159], v24, s[48:51], 0 offen offset:0 sc1
    s_or_b64 exec, s[6:7], 1
    buffer_load_dwordx4 v[160:163], v24, s[48:51], 0 offen offset:1024 sc1
L_p2_chk:
    s_mov_b64 exec, s[4:5]
    s_waitcnt vmcnt(0)
    s_cbranch_execz L_p2_z00
    v_bitop3_b32 v29, v156, v157, s31 bitop3:0x7e
    v_bitop3_b32 v30, v158, v159, s31 bitop3:0x7e
    v_bitop3_b32 v29, v29, v30, s68 bitop3:0xa8
    v_and_b32 v144, s67, v156
    v_and_b32 v145, s67, v157
    v_and_b32 v146, s67, v158
    v_and_b32 v147, s67, v159
    v_cmp_ne_u32 s[4:5], 0, v29
L_p2_z00:
    s_mov_b64 exec, s[6:7]
    s_cbranch_execz L_p2_z01
    v_bitop3_b32 v29, v160, v161, s31 bitop3:0x7e
    v_bitop3_b32 v30, v162, v163, s31 bitop3:0x7e
    v_bitop3_b32 v29, v29, v30, s68 bitop3:0xa8
    v_and_b32 v148, s67, v160
    v_and_b32 v149, s67, v161
    v_and_b32 v150, s67, v162
    v_and_b32 v151, s67, v163
    v_cmp_ne_u32 s[6:7], 0, v29
L_p2_z01:
    s_or_b64 vcc, s[4:5], s[6:7]
    s_cbranch_scc0 L_p2_ok
    s_sub_u32 s70, s70, 1
    s_cmp_lg_u32 s70, 0
    s_cbranch_scc1 L_p2
L_p2_ok:
    s_mov_b64 exec, -1
    v_pk_add_f32 v[144:145], v[144:145], v[148:149]
    v_pk_add_f32 v[146:147], v[146:147], v[150:151]
    v_lshlrev_b32 v154, 16, v154
    v_permlane16_swap_b32 v144, v145
    v_permlane16_swap_b32 v146, v147
    v_add_f32 v144, v144, v145
    v_add_f32 v146, v146, v147
    s_nop 1
    v_permlane32_swap_b32 v144, v146
    v_add_f32 v144, v144, v146
    v_add_f32 v144, v144, v154
    v_cvt_pk_bf16_f32 v146, v144, v144
    v_and_b32 v144, s66, v146
    ds_write_b32 v45, v146
    ds_read_b128 v[148:151], v46
    ds_read_b128 v[8:11], v46 offset:16
    v_mul_f32 v145, v144, v144
    v_add_f32_dpp v144, v144, v144 row_ror:8 row_mask:0xf bank_mask:0xf
    s_nop 0
    v_add_f32_dpp v145, v145, v145 row_ror:8 row_mask:0xf bank_mask:0xf
    v_add_f32_dpp v144, v144, v144 row_ror:4 row_mask:0xf bank_mask:0xf
    s_nop 0
    v_add_f32_dpp v145, v145, v145 row_ror:4 row_mask:0xf bank_mask:0xf
    v_add_f32_dpp v144, v144, v144 row_ror:2 row_mask:0xf bank_mask:0xf
    s_nop 0
    v_add_f32_dpp v145, v145, v145 row_ror:2 row_mask:0xf bank_mask:0xf
    v_add_f32_dpp v144, v144, v144 row_ror:1 row_mask:0xf bank_mask:0xf
    s_nop 0
    v_add_f32_dpp v145, v145, v145 row_ror:1 row_mask:0xf bank_mask:0xf
    s_waitcnt lgkmcnt(1)
    v_and_b32 v16, v148, v4
    v_and_b32 v17, v148, v5
    v_and_b32 v18, v148, v6
    v_and_b32 v19, v148, v7
    v_and_b32 v20, v149, v4
    v_and_b32 v21, v149, v5
    v_and_b32 v22, v149, v6
    v_and_b32 v23, v149, v7
    v_mfma_f32_16x16x32_bf16 v[12:15], v[108:111], v[16:19], 0
    v_and_b32 v16, v150, v4
    v_and_b32 v17, v150, v5
    v_and_b32 v18, v150, v6
    v_and_b32 v19, v150, v7
    v_mfma_f32_16x16x32_bf16 v[12:15], v[112:115], v[20:23], v[12:15]
    v_and_b32 v20, v151, v4
    v_and_b32 v21, v151, v5
    v_and_b32 v22, v151, v6
    v_and_b32 v23, v151, v7
    v_mfma_f32_16x16x32_bf16 v[12:15], v[116:119], v[16:19], v[12:15]
    s_waitcnt lgkmcnt(0)
    v_and_b32 v16, v8, v4
    v_and_b32 v17, v8, v5
    v_and_b32 v18, v8, v6
    v_and_b32 v19, v8, v7
    v_mfma_f32_16x16x32_bf16 v[12:15], v[120:123], v[20:23], v[12:15]
    v_and_b32 v20, v9, v4
    v_and_b32 v21, v9, v5
    v_and_b32 v22, v9, v6
    v_and_b32 v23, v9, v7
    v_mfma_f32_16x16x32_bf16 v[12:15], v[124:127], v[16:19], v[12:15]
    v_and_b32 v16, v10, v4
    v_and_b32 v17, v10, v5
    v_and_b32 v18, v10, v6
    v_and_b32 v19, v10, v7
    v_mfma_f32_16x16x32_bf16 v[12:15], v[128:131], v[20:23], v[12:15]
    v_and_b32 v20, v11, v4
    v_and_b32 v21, v11, v5
    v_and_b32 v22, v11, v6
    v_and_b32 v23, v11, v7
    v_mfma_f32_16x16x32_bf16 v[12:15], v[132:135], v[16:19], v[12:15]
    s_nop 0
    v_mfma_f32_16x16x32_bf16 v[12:15], v[136:139], v[20:23], v[12:15]
    s_cmp_ge_u32 s28, 4
    s_cbranch_scc1 L_w2e
    buffer_load_dwordx4 v[76:79], v2, s[52:55], 0 offen offset:0
    buffer_load_dwordx4 v[92:95], v2, s[52:55], 0 offen offset:512
    buffer_load_dwordx4 v[140:143], v2, s[52:55], s12 offen offset:1024
    buffer_load_dwordx4 v[80:83], v2, s[52:55], 0 offen offset:2304
    buffer_load_dwordx4 v[96:99], v2, s[52:55], 0 offen offset:2816
    buffer_load_dwordx4 v[164:167], v2, s[52:55], s12 offen offset:3328
    buffer_load_dwordx4 v[84:87], v2, s[52:55], s76 offen offset:0
    buffer_load_dwordx4 v[100:103], v2, s[52:55], s76 offen offset:512
    buffer_load_dwordx4 v[52:55], v2, s[52:55], s13 offen offset:1024
    buffer_load_dwordx4 v[88:91], v2, s[52:55], s76 offen offset:2304
    buffer_load_dwordx4 v[104:107], v2, s[52:55], s76 offen offset:2816
    buffer_load_dwordx4 v[56:59], v2, s[52:55], s13 offen offset:3328
L_w2e:
    v_permlane16_swap_b32 v144, v145
    v_add_f32 v144, v144, v145
    v_mov_b32 v145, v144
    s_nop 1
    v_permlane32_swap_b32 v144, v145
    v_add_f32 v144, v144, v145
    v_permlane32_swap_b32 v12, v40
    v_permlane32_swap_b32 v13, v41
    v_permlane32_swap_b32 v14, v42
    v_permlane32_swap_b32 v15, v43
    s_mov_b64 exec, 0x00010001
    ds_write_b32 v25, v144 offset:0
    s_mov_b64 exec, -1
    v_add_f32_dpp v12, v40, v12 row_ror:8 row_mask:0x3 bank_mask:0xf
    v_add_f32_dpp v13, v41, v13 row_ror:8 row_mask:0x3 bank_mask:0xf
    v_add_f32_dpp v14, v42, v14 row_ror:8 row_mask:0x3 bank_mask:0xf
    v_add_f32_dpp v15, v43, v15 row_ror:8 row_mask:0x3 bank_mask:0xf
    s_mov_b32 exec_lo, 0xff00ff
    s_mov_b32 exec_hi, 0xff00ff
    ds_write_b128 v26, v[12:15]
    s_mov_b64 exec, -1
    s_waitcnt lgkmcnt(0)
    s_barrier
    s_cmp_ge_u32 s28, 4
    s_cbranch_scc1 L_done
    ds_read_b64 v[28:29], v39 offset:0
    ds_read_b128 v[144:147], v37 offset:4096
    ds_read_b128 v[148:151], v37 offset:4608
    ds_read_b128 v[8:11], v37 offset:5120
    ds_read_b128 v[152:155], v37 offset:5632
    ds_read_b128 v[40:43], v44 offset:8192
    s_waitcnt lgkmcnt(5)
    v_add_f32_dpp v28, v28, v28 row_ror:8 row_mask:0xf bank_mask:0xf
    v_add_f32_dpp v29, v29, v29 row_ror:8 row_mask:0xf bank_mask:0xf
    s_waitcnt lgkmcnt(3)
    v_pk_add_f32 v[144:145], v[144:145], v[148:149]
    v_add_f32_dpp v28, v28, v28 row_ror:4 row_mask:0xf bank_mask:0xf
    v_add_f32_dpp v29, v29, v29 row_ror:4 row_mask:0xf bank_mask:0xf
    v_pk_add_f32 v[146:147], v[146:147], v[150:151]
    v_add_f32_dpp v28, v28, v28 row_ror:2 row_mask:0xf bank_mask:0xf
    v_add_f32_dpp v29, v29, v29 row_ror:2 row_mask:0xf bank_mask:0xf
    s_waitcnt lgkmcnt(2)
    v_pk_add_f32 v[144:145], v[144:145], v[8:9]
    v_add_f32_dpp v28, v28, v28 row_ror:1 row_mask:0xf bank_mask:0xf
    v_add_f32_dpp v29, v29, v29 row_ror:1 row_mask:0xf bank_mask:0xf
    v_pk_add_f32 v[146:147], v[146:147], v[10:11]
    v_mul_f32 v28, 0x3ae38e39, v28
    v_mul_f32 v29, 0x3ae38e39, v29
    s_waitcnt lgkmcnt(1)
    v_pk_add_f32 v[144:145], v[144:145], v[152:153]
    v_fma_f32 v29, -v28, v28, v29
    v_pk_add_f32 v[146:147], v[146:147], v[154:155]
    v_max_f32 v29, 0, v29
    s_waitcnt lgkmcnt(0)
    v_pk_fma_f32 v[144:145], v[40:41], s[10:11], v[144:145]
    v_add_f32 v29, 0x3727c5ac, v29
    v_pk_fma_f32 v[146:147], v[42:43], s[10:11], v[146:147]
    v_rsq_f32 v29, v29
    v_permlane16_swap_b32 v144, v145
    v_permlane16_swap_b32 v146, v147
    v_fma_f32 v144, v145, -v28, v144
    v_fma_f32 v146, v147, -v28, v146
    s_nop 1
    v_permlane32_swap_b32 v144, v146
    v_add_f32 v144, v144, v146
    v_mul_f32 v144, v144, v29
    v_mul_f32 v146, 0xbfb8aa3b, v144
    v_exp_f32 v146, v146
    v_mul_f32_dpp v144, v144, v144 row_ror:8 row_mask:0xf bank_mask:0xf
    v_add_f32 v146, 1.0, v146
    v_rcp_f32 v146, v146
    s_nop 0
    v_mul_f32 v144, v144, v146
    v_cvt_pk_bf16_f32 v144, v144, v144
    s_nop 1
    v_mov_b32_dpp v34, v144 row_newbcast:0 row_mask:0xf bank_mask:0x3
    v_mov_b32_dpp v34, v144 row_newbcast:1 row_mask:0xf bank_mask:0xc
    v_and_b32 v16, v34, v4
    v_and_b32 v17, v34, v5
    v_and_b32 v18, v34, v6
    v_and_b32 v19, v34, v7
    v_mov_b32_dpp v35, v144 row_newbcast:2 row_mask:0xf bank_mask:0x3
    v_mov_b32_dpp v35, v144 row_newbcast:3 row_mask:0xf bank_mask:0xc
    s_waitcnt vmcnt(11)
    v_mfma_f32_16x16x32_bf16 v[12:15], v[76:79], v[16:19], 0
    s_waitcnt vmcnt(10)
    v_mfma_f32_16x16x32_bf16 v[8:11], v[92:95], v[16:19], 0
    s_waitcnt vmcnt(9)
    v_mfma_f32_16x16x32_bf16 v[40:43], v[140:143], v[16:19], 0
    v_and_b32 v20, v35, v4
    v_and_b32 v21, v35, v5
    v_and_b32 v22, v35, v6
    v_and_b32 v23, v35, v7
    v_mov_b32_dpp v34, v144 row_newbcast:4 row_mask:0xf bank_mask:0x3
    v_mov_b32_dpp v34, v144 row_newbcast:5 row_mask:0xf bank_mask:0xc
    s_waitcnt vmcnt(8)
    v_mfma_f32_16x16x32_bf16 v[12:15], v[80:83], v[20:23], v[12:15]
    s_waitcnt vmcnt(7)
    v_mfma_f32_16x16x32_bf16 v[8:11], v[96:99], v[20:23], v[8:11]
    s_waitcnt vmcnt(6)
    v_mfma_f32_16x16x32_bf16 v[40:43], v[164:167], v[20:23], v[40:43]
    v_and_b32 v16, v34, v4
    v_and_b32 v17, v34, v5
    v_and_b32 v18, v34, v6
    v_and_b32 v19, v34, v7
    v_mov_b32_dpp v35, v144 row_newbcast:6 row_mask:0xf bank_mask:0x3
    v_mov_b32_dpp v35, v144 row_newbcast:7 row_mask:0xf bank_mask:0xc
    s_waitcnt vmcnt(5)
    v_mfma_f32_16x16x32_bf16 v[12:15], v[84:87], v[16:19], v[12:15]
    s_waitcnt vmcnt(4)
    v_mfma_f32_16x16x32_bf16 v[8:11], v[100:103], v[16:19], v[8:11]
    s_waitcnt vmcnt(3)
    v_mfma_f32_16x16x32_bf16 v[40:43], v[52:55], v[16:19], v[40:43]
    v_and_b32 v20, v35, v4
    v_and_b32 v21, v35, v5
    v_and_b32 v22, v35, v6
    v_and_b32 v23, v35, v7
    s_waitcnt vmcnt(2)
    s_nop 0
    v_mfma_f32_16x16x32_bf16 v[12:15], v[88:91], v[20:23], v[12:15]
    s_waitcnt vmcnt(1)
    v_mfma_f32_16x16x32_bf16 v[8:11], v[104:107], v[20:23], v[8:11]
    s_waitcnt vmcnt(0)
    v_mfma_f32_16x16x32_bf16 v[40:43], v[56:59], v[20:23], v[40:43]
    s_mov_b32 s10, 147456
    s_mov_b32 s11, 294912
    s_nop 1
    v_permlane32_swap_b32 v12, v28
    v_permlane32_swap_b32 v13, v29
    v_permlane32_swap_b32 v14, v30
    v_permlane32_swap_b32 v15, v31
    v_add_f32_dpp v12, v28, v12 row_ror:8 row_mask:0xf bank_mask:0xf
    v_add_f32_dpp v13, v29, v13 row_ror:8 row_mask:0xf bank_mask:0xf
    v_add_f32_dpp v14, v30, v14 row_ror:8 row_mask:0xf bank_mask:0xf
    v_add_f32_dpp v15, v31, v15 row_ror:8 row_mask:0xf bank_mask:0xf
    v_and_or_b32 v12, v12, s67, v3
    v_and_or_b32 v13, v13, s67, v3
    v_and_or_b32 v14, v14, s67, v3
    v_and_or_b32 v15, v15, s67, v3
    s_mov_b64 exec, 0x00ff00ff
    buffer_store_dwordx4 v[12:15], v38, s[48:51], 0 offen sc1
    s_mov_b64 exec, -1
    v_permlane32_swap_b32 v8, v28
    v_permlane32_swap_b32 v9, v29
    v_permlane32_swap_b32 v10, v30
    v_permlane32_swap_b32 v11, v31
    v_add_f32_dpp v8, v28, v8 row_ror:8 row_mask:0xf bank_mask:0xf
    v_add_f32_dpp v9, v29, v9 row_ror:8 row_mask:0xf bank_mask:0xf
    v_add_f32_dpp v10, v30, v10 row_ror:8 row_mask:0xf bank_mask:0xf
    v_add_f32_dpp v11, v31, v11 row_ror:8 row_mask:0xf bank_mask:0xf
    v_and_or_b32 v8, v8, s67, v3
    v_and_or_b32 v9, v9, s67, v3
    v_and_or_b32 v10, v10, s67, v3
    v_and_or_b32 v11, v11, s67, v3
    s_mov_b64 exec, 0x00ff00ff
    buffer_store_dwordx4 v[8:11], v38, s[48:51], s10 offen sc1
    s_cmp_lg_u32 s28, 0
    s_cbranch_scc1 L_done
    s_mov_b64 exec, -1
    v_permlane32_swap_b32 v40, v28
    v_permlane32_swap_b32 v41, v29
    v_permlane32_swap_b32 v42, v30
    v_permlane32_swap_b32 v43, v31
    v_add_f32_dpp v40, v28, v40 row_ror:8 row_mask:0xf bank_mask:0xf
    v_add_f32_dpp v41, v29, v41 row_ror:8 row_mask:0xf bank_mask:0xf
    v_add_f32_dpp v42, v30, v42 row_ror:8 row_mask:0xf bank_mask:0xf
    v_add_f32_dpp v43, v31, v43 row_ror:8 row_mask:0xf bank_mask:0xf
    v_and_or_b32 v40, v40, s67, v3
    v_and_or_b32 v41, v41, s67, v3
    v_and_or_b32 v42, v42, s67, v3
    v_and_or_b32 v43, v43, s67, v3
    s_mov_b64 exec, 0x00ff00ff
    buffer_store_dwordx4 v[40:43], v38, s[48:51], s11 offen sc1
    s_branch L_done
L_red:
    s_sub_u32 s69, s79, 216
    v_and_b32 v32, 3, v0
    v_lshrrev_b32 v33, 4, v0
    s_lshr_b32 s3, s69, 1
    s_lshl_b32 s3, s3, 5
    s_and_b32 s62, s69, 1
    s_lshl_b32 s62, s62, 2
    s_add_u32 s3, s3, s62
    v_lshl_add_u32 v27, v33, 3, v32
    v_add_u32 v27, s3, v27
    v_lshlrev_b32 v27, 1, v27
    v_lshl_add_u32 v1, v33, 2, v32
    v_mul_u32_u24 v1, 48, v1
    s_lshl_b32 s3, s28, 2
    v_add_u32 v26, s3, v1
    s_cmp_lg_u32 s28, 0
    s_cbranch_scc1 L_red_h3
    buffer_load_ushort v8, v27, s[44:47], 0 offen
    s_lshr_b32 s62, s69, 2
    s_lshl_b32 s62, s62, 11
    s_and_b32 s3, s69, 3
    s_lshl_b32 s3, s3, 6
    s_add_u32 s3, s3, s62
    s_and_b32 s62, s2, 7
    s_lshl_b32 s62, s62, 15
    s_add_u32 s3, s3, s62
    s_add_u32 s3, s3, 1310720
    v_bfe_u32 v24, v0, 2, 3
    v_lshlrev_b32 v24, 8, v24
    v_lshl_add_u32 v24, v32, 4, v24
    v_add_u32 v24, s3, v24
    s_mov_b32 s70, 0x40000
    s_mov_b64 s[4:5], -1
L_p2r:
    buffer_load_dwordx4 v[112:115], v24, s[48:51], 0 offen sc1
    s_waitcnt vmcnt(0)
    v_bitop3_b32 v29, v112, v113, s31 bitop3:0x7e
    v_bitop3_b32 v30, v114, v115, s31 bitop3:0x7e
    v_bitop3_b32 v29, v29, v30, s68 bitop3:0xa8
    v_cmp_ne_u32 s[4:5], 0, v29
    s_and_b64 exec, s[4:5], s[4:5]
    s_cbranch_scc0 L_p2r_ok
    s_sleep 2
    s_sub_u32 s70, s70, 1
    s_cmp_lg_u32 s70, 0
    s_cbranch_scc1 L_p2r
L_p2r_ok:
    s_mov_b64 exec, -1
    v_and_b32 v112, s67, v112
    v_and_b32 v113, s67, v113
    v_and_b32 v114, s67, v114
    v_and_b32 v115, s67, v115
    v_permlane16_swap_b32 v112, v113
    s_nop 0
    v_permlane16_swap_b32 v114, v115
    v_add_f32 v112, v112, v113
    v_add_f32 v114, v114, v115
    s_nop 1
    v_permlane32_swap_b32 v112, v114
    v_add_f32 v112, v112, v114
    s_nop 1
    v_add_f32_dpp v112, v112, v112 row_ror:4 row_mask:0xf bank_mask:0xf
    s_nop 1
    v_add_f32_dpp v112, v112, v112 row_ror:8 row_mask:0xf bank_mask:0xf
    v_mul_f32 v112, 0.5, v112
    v_lshlrev_b32 v8, 16, v8
    v_add_f32 v112, v112, v8
    v_cvt_pk_bf16_f32 v112, v112, v112
    v_and_b32 v112, s66, v112
L_red_h3:
    s_mul_i32 s3, s69, 9216
    s_lshl_b32 s62, s28, 10
    s_add_u32 s3, s3, s62
    s_add_u32 s3, s3, 262144
    v_lshl_add_u32 v25, v0, 4, s3
    s_mov_b32 s70, 0x40000
    s_mov_b64 s[4:5], -1
L_p3:
    s_or_b64 exec, s[4:5], 1
    buffer_load_dwordx4 v[116:119], v25, s[48:51], 0 offen sc1
    s_mov_b64 exec, s[4:5]
    s_waitcnt vmcnt(0)
    v_bitop3_b32 v29, v116, v117, s31 bitop3:0x7e
    v_bitop3_b32 v30, v118, v119, s31 bitop3:0x7e
    v_bitop3_b32 v29, v29, v30, s68 bitop3:0xa8
    v_and_b32 v108, s67, v116
    v_and_b32 v109, s67, v117
    v_and_b32 v110, s67, v118
    v_and_b32 v111, s67, v119
    v_cmp_ne_u32 s[4:5], 0, v29
    s_cmp_lg_u64 s[4:5], 0
    s_cbranch_scc0 L_p3_ok
    s_sub_u32 s70, s70, 1
    s_cmp_lg_u32 s70, 0
    s_cbranch_scc1 L_p3
L_p3_ok:
    s_mov_b64 exec, -1
    v_permlane16_swap_b32 v108, v109
    v_permlane16_swap_b32 v110, v111
    v_add_f32 v108, v108, v109
    v_add_f32 v110, v110, v111
    s_nop 1
    v_permlane32_swap_b32 v108, v110
    v_add_f32 v108, v108, v110
    s_nop 1
    v_add_f32_dpp v108, v108, v108 row_ror:4 row_mask:0xf bank_mask:0xf
    s_nop 1
    v_add_f32_dpp v108, v108, v108 row_ror:8 row_mask:0xf bank_mask:0xf
    s_mov_b32 exec_lo, 0xf000f
    s_mov_b32 exec_hi, 0xf000f
    ds_write_b32 v26, v108 offset:4096
    s_waitcnt lgkmcnt(0)
    s_barrier
    s_cmp_lg_u32 s28, 0
    s_cbranch_scc1 L_done
    ds_read_b128 v[108:111], v1 offset:4096
    ds_read_b128 v[16:19], v1 offset:4112
    ds_read_b32 v20, v1 offset:4128
    s_waitcnt lgkmcnt(1)
    v_pk_add_f32 v[108:109], v[108:109], v[16:17]
    v_pk_add_f32 v[110:111], v[110:111], v[18:19]
    v_add_f32 v108, v108, v109
    v_add_f32 v110, v110, v111
    s_waitcnt lgkmcnt(0)
    v_add_f32 v108, v108, v20
    v_add_f32 v108, v108, v110
    v_add_f32 v108, v108, v112
    v_cvt_pk_bf16_f32 v108, v108, v108
    buffer_store_short v108, v27, s[56:59], 0 offen
    s_cmp_lg_u32 s69, 0
    s_cbranch_scc1 L_done
    s_mov_b64 exec, 1
    v_mov_b32 v28, s71
    v_mov_b32 v29, 0
    buffer_store_dword v28, v29, s[48:51], 0 offen
L_done:
L_exit:
    s_endpgm
L_end:
.section .rodata,"a"
.p2align 6
.amdhsa_kernel sequential_preLN__mha_block_cached__glu_gated_swiglu__decode_kernel
  .amdhsa_next_free_vgpr 168
  .amdhsa_next_free_sgpr 80
  .amdhsa_accum_offset 168
  .amdhsa_group_segment_fixed_size 0
  .amdhsa_kernarg_size 96
  .amdhsa_user_sgpr_count 2
  .amdhsa_user_sgpr_kernarg_segment_ptr 1
  .amdhsa_system_sgpr_workgroup_id_x 1
.end_amdhsa_kernel
```
